```python
import torch

def _softmax(x, axis=-1):
    return torch.softmax(x, dim=axis)
def _gelu(x):
    return torch.nn.functional.gelu(x, approximate="tanh")
def _silu(x):
    return torch.nn.functional.silu(x)
def _sigmoid(x):
    return torch.sigmoid(x)
def _layernorm(x, axis=-1, eps=1e-5):
    m = x.mean(dim=axis, keepdim=True)
    v = x.var(dim=axis, keepdim=True, unbiased=False)
    return (x - m) / torch.sqrt(v + eps)
def _scatter_add(tgt, idx, src, axis=0):
    return tgt.clone().index_add_(axis, idx, src)
def _segment_sum(src, seg, n):
    out = torch.zeros((n,) + src.shape[1:], dtype=src.dtype)
    return out.index_add_(0, seg, src)
def _pad(x, pw):
    flat = tuple(v for pair in reversed(pw) for v in pair)
    return torch.nn.functional.pad(x, flat)

kernel_name = 'sequential_preLN__compressed_kv_cla__glu_gated_geglu__decode'

def setup_inputs():

    _w = (lambda a: (lambda t: t.to(torch.bfloat16) if t.is_floating_point() else t)(torch.as_tensor(a)))
    def _A_setup():
        B, H, Sq, Sk, D, M = 4, 32, 1, 8192, 128, 512
        Dc = 4 * D
        return {
            "x": _w((lambda *s: torch.randn(*s, dtype=torch.bfloat16) * 0.05)(B, Sq, M)),
            "c_kv": _w((lambda *s: torch.randn(*s, dtype=torch.bfloat16) * 0.8)(B, Sk, Dc)),
            "w_q": _w((lambda *s: torch.randn(*s, dtype=torch.bfloat16) * 1.6)(M, H, D) * (M ** -0.5)),
            "w_uk": _w((lambda *s: torch.randn(*s, dtype=torch.bfloat16) * 1.6)(Dc, H, D) * (Dc ** -0.5)),
            "w_uv": _w((lambda *s: torch.randn(*s, dtype=torch.bfloat16) * 0.8)(Dc, H, D) * (Dc ** -0.5)),
            "w_o": _w((lambda *s: torch.randn(*s, dtype=torch.bfloat16) * 0.8)(H, D, M) * ((H * D) ** -0.5)),
        }
    _A_in = _A_setup()

    def _B_setup():
        B, S, Dm, Df = 4, 1, 512, 1376
        return {
            "x": _w((lambda *s: torch.randn(*s, dtype=torch.bfloat16) * 0.05)(B, S, Dm)),
            "w_gate": _w((lambda *s: torch.randn(*s, dtype=torch.bfloat16) * 0.4)(Dm, Df) * (Dm ** -0.5)),
            "w_up": _w((lambda *s: torch.randn(*s, dtype=torch.bfloat16) * 0.4)(Dm, Df) * (Dm ** -0.5)),
            "w_down": _w((lambda *s: torch.randn(*s, dtype=torch.bfloat16) * 0.4)(Df, Dm) * (Df ** -0.5)),
        }
    _B_in = _B_setup()

    return {
        "A_x": _A_in["x"],
        "A_c_kv": _A_in["c_kv"],
        "A_w_q": _A_in["w_q"],
        "A_w_uk": _A_in["w_uk"],
        "A_w_uv": _A_in["w_uv"],
        "A_w_o": _A_in["w_o"],
        "B_x": _B_in["x"],
        "B_w_gate": _B_in["w_gate"],
        "B_w_up": _B_in["w_up"],
        "B_w_down": _B_in["w_down"],
    }

def reference(A_x, A_c_kv, A_w_q, A_w_uk, A_w_uv, A_w_o, B_x, B_w_gate, B_w_up, B_w_down):
    def _A_ref(x, c_kv, w_q, w_uk, w_uv, w_o):
        B, Sq, M = x.shape[0], x.shape[1], x.shape[2]
        Sk = c_kv.shape[1]
        H, D = w_q.shape[1], w_q.shape[2]
        q = torch.einsum("bqm,mhd->bhqd", x, w_q)
        k = torch.einsum("bkc,chd->bhkd", c_kv, w_uk)
        v = torch.einsum("bkc,chd->bhkd", c_kv, w_uv)
        scores = torch.einsum("bhqd,bhkd->bhqk", q, k) * (D ** -0.5)
        off = Sk - Sq
        qi = torch.arange(Sq)[:, None]
        kj = torch.arange(Sk)[None, :]
        cmask = kj <= (qi + off)
        scores = torch.where(cmask[None, None], scores, -1e9)
        p = _softmax(scores, axis=-1)
        ctx = torch.einsum("bhqk,bhkd->bhqd", p, v)
        return torch.einsum("bhqd,hdm->bqm", ctx, w_o)

    def _B_ref(x, w_gate, w_up, w_down):
        g = torch.einsum("bsd,df->bsf", x, w_gate)
        u = torch.einsum("bsd,df->bsf", x, w_up)
        h = _gelu(g) * u
        return torch.einsum("bsf,fd->bsd", h, w_down)

    x = A_x
    h = x + _A_ref(_layernorm(x, axis=-1), A_c_kv, A_w_q, A_w_uk, A_w_uv, A_w_o)
    h2 = h + _B_ref(_layernorm(h, axis=-1), B_w_gate, B_w_up, B_w_down)
    return h2
```

```asm
; @launch grid=(256,1,1) block=(256,1,1) lds=163840
.amdgcn_target "amdgcn-amd-amdhsa--gfx950"
.text
.globl sequential_preLN__compressed_kv_cla__glu_gated_geglu__decode_kernel
.p2align 8
.type sequential_preLN__compressed_kv_cla__glu_gated_geglu__decode_kernel,@function
sequential_preLN__compressed_kv_cla__glu_gated_geglu__decode_kernel:
s_load_dwordx16 s[16:31], s[0:1], 0
s_load_dwordx8 s[32:39], s[0:1], 64
s_load_dwordx2 s[40:41], s[0:1], 96
s_cmp_ge_u32 s2, 256
s_cbranch_scc1 L_end
s_getpc_b64 s[4:5]
s_and_b32 s5, s5, 0xffff
s_mov_b32 s6, L_end - L_pcv
s_mov_b32 s7, 0x20000
L_pcv:
s_bfe_u32 s62, s2, 0x40003
s_lshl_b32 s62, s62, 12
v_lshlrev_b32 v1, 4, v0
buffer_load_dwordx4 v[252:255], v1, s[4:7], s62 offen
v_lshrrev_b32 v2, 6, v0
v_and_b32 v1, 63, v0
v_readfirstlane_b32 s3, v2
v_and_b32 v2, 15, v0
v_lshrrev_b32 v3, 4, v1
s_and_b32 s62, s2, 7
s_lshr_b32 s43, s2, 4
s_lshl_b32 s42, s43, 3
s_or_b32 s42, s42, s62
s_and_b32 s73, s43, 3
s_lshr_b32 s43, s43, 2
s_lshl_b32 s72, s62, 2
s_or_b32 s72, s72, s43
s_lshl_b32 s43, s43, 3
s_or_b32 s43, s43, s62
s_mov_b32 s60, 0x05040100
s_mov_b32 s61, 0x07060302
s_bitcmp1_b32 s2, 3
s_cbranch_scc1 L_A
s_lshl_b32 s74, s72, 10
s_lshl_b32 s62, s73, 8
s_add_u32 s74, s74, s62
s_lshl_b32 s62, s3, 6
s_add_u32 s74, s74, s62
v_lshlrev_b32 v28, 15, v3
v_lshl_add_u32 v28, v2, 2, v28
s_lshl_b32 s75, s73, 5
s_add_u32 s75, s75, s72
v_lshlrev_b32 v29, 4, v0
s_lshl_b32 s76, s75, 12
s_add_u32 s76, s76, 262144
v_lshlrev_b32 v4, 16, v3
v_lshl_add_u32 v4, v2, 4, v4
s_lshl_b32 s66, s3, 20
s_lshl_b32 s63, s72, 8
s_add_u32 s66, s66, s63
s_xor_b32 s63, s73, 0
s_lshl_b32 s63, s63, 18
s_add_u32 s52, s66, s63
s_xor_b32 s63, s73, 1
s_lshl_b32 s63, s63, 18
s_add_u32 s53, s66, s63
s_xor_b32 s63, s73, 2
s_lshl_b32 s63, s63, 18
s_add_u32 s54, s66, s63
s_xor_b32 s63, s73, 3
s_lshl_b32 s63, s63, 18
s_add_u32 s55, s66, s63
v_lshlrev_b32 v5, 14, v2
v_lshl_add_u32 v5, v3, 4, v5
s_lshl_b32 s78, s73, 20
s_lshl_b32 s63, s3, 18
s_add_u32 s78, s78, s63
s_lshl_b32 s63, s72, 8
s_add_u32 s78, s78, s63
s_add_u32 s79, s78, 8192
s_lshr_b32 s67, s42, 5
s_mov_b32 s14, 0x400000
s_mov_b32 s15, 0x20000
s_mov_b32 s58, 4096
s_mov_b32 s59, 0x20000
s_mov_b32 s46, 0x400000
s_mov_b32 s47, 0x20000
s_waitcnt lgkmcnt(0)
s_mov_b32 s56, s16
s_and_b32 s57, s17, 0xffff
s_mov_b32 s12, s20
s_and_b32 s13, s21, 0xffff
buffer_load_dwordx4 v[8:11], v29, s[56:59], 0 offen
s_add_u32 s63, s52, 0
buffer_load_dwordx4 v[32:35], v4, s[12:15], s63 offen
s_add_u32 s63, s52, 8192
buffer_load_dwordx4 v[36:39], v4, s[12:15], s63 offen
s_add_u32 s63, s52, 16384
buffer_load_dwordx4 v[40:43], v4, s[12:15], s63 offen
s_add_u32 s63, s52, 24576
buffer_load_dwordx4 v[44:47], v4, s[12:15], s63 offen
s_add_u32 s63, s52, 32768
buffer_load_dwordx4 v[48:51], v4, s[12:15], s63 offen
s_add_u32 s63, s52, 40960
buffer_load_dwordx4 v[52:55], v4, s[12:15], s63 offen
s_add_u32 s63, s52, 49152
buffer_load_dwordx4 v[56:59], v4, s[12:15], s63 offen
s_add_u32 s63, s52, 57344
buffer_load_dwordx4 v[60:63], v4, s[12:15], s63 offen
s_mov_b32 s44, s22
s_and_b32 s45, s23, 0xffff
s_barrier
s_cmp_eq_u32 s67, 1
s_cbranch_scc1 ic_1
buffer_load_dwordx4 v[160:163], v5, s[44:47], s78 offen offset:0
buffer_load_dwordx4 v[164:167], v5, s[44:47], s78 offen offset:64
buffer_load_dwordx4 v[168:171], v5, s[44:47], s78 offen offset:128
buffer_load_dwordx4 v[172:175], v5, s[44:47], s78 offen offset:192
buffer_load_dwordx4 v[176:179], v5, s[44:47], s79 offen offset:0
buffer_load_dwordx4 v[180:183], v5, s[44:47], s79 offen offset:64
buffer_load_dwordx4 v[184:187], v5, s[44:47], s79 offen offset:128
buffer_load_dwordx4 v[188:191], v5, s[44:47], s79 offen offset:192
ic_1:
s_mov_b32 s4, s40
s_and_b32 s5, s41, 0xffff
s_mov_b32 s6, 268435456
s_mov_b32 s7, 0x20000
s_mov_b32 s8, s38
s_and_b32 s9, s39, 0xffff
s_mov_b32 s10, 256
s_mov_b32 s11, 0x20000
v_mov_b32 v24, -1
v_mov_b32 v25, -1
v_mov_b32 v26, -1
v_mov_b32 v27, -1
buffer_store_dwordx4 v[24:27], v29, s[4:7], s76 offen sc1
v_lshlrev_b32 v30, 3, v0
s_lshl_b32 s62, s42, 11
s_add_u32 s62, s62, 6291456
buffer_store_dwordx2 v[24:25], v30, s[4:7], s62 offen sc1
v_lshlrev_b32 v30, 2, v0
s_lshl_b32 s62, s42, 10
s_add_u32 s62, s62, 5242880
buffer_store_dword v24, v30, s[4:7], s62 offen sc1
s_mul_i32 s62, s3, 1040
v_lshlrev_b32 v6, 4, v1
v_add_u32 v6, s62, v6
v_and_b32 v7, 3, v2
v_mul_u32_u24 v7, 1040, v7
v_lshl_add_u32 v7, v3, 4, v7
s_lshl_b32 s62, s3, 8
v_add_u32 v7, s62, v7
s_waitcnt vmcnt(19)
s_cmp_eq_u32 s67, 1
s_cbranch_scc0 ic_2
s_waitcnt vmcnt(11)
ic_2:
v_lshlrev_b32 v12, 16, v8
v_and_b32 v13, 0xffff0000, v8
v_lshlrev_b32 v14, 16, v9
v_and_b32 v15, 0xffff0000, v9
v_lshlrev_b32 v16, 16, v10
v_and_b32 v17, 0xffff0000, v10
v_lshlrev_b32 v18, 16, v11
v_and_b32 v19, 0xffff0000, v11
v_add_f32 v20, v12, v13
v_add_f32 v21, v14, v15
v_add_f32 v22, v16, v17
v_add_f32 v23, v18, v19
v_add_f32 v20, v20, v21
v_add_f32 v22, v22, v23
v_add_f32 v20, v20, v22
s_nop 1
v_add_f32_dpp v20, v20, v20 quad_perm:[1,0,3,2] row_mask:0xf bank_mask:0xf
s_nop 1
v_add_f32_dpp v20, v20, v20 quad_perm:[2,3,0,1] row_mask:0xf bank_mask:0xf
s_nop 1
v_add_f32_dpp v20, v20, v20 row_half_mirror row_mask:0xf bank_mask:0xf
s_nop 1
v_add_f32_dpp v20, v20, v20 row_mirror row_mask:0xf bank_mask:0xf
v_mov_b32 v21, v20
s_nop 1
v_permlane16_swap_b32 v20, v21
v_add_f32 v20, v20, v21
v_mov_b32 v21, v20
s_nop 1
v_permlane32_swap_b32 v20, v21
v_add_f32 v20, v20, v21
v_mul_f32 v20, 0x3b000000, v20
v_sub_f32 v22, v12, v20
v_mul_f32 v21, v22, v22
v_sub_f32 v22, v13, v20
v_fmac_f32 v21, v22, v22
v_sub_f32 v22, v14, v20
v_fmac_f32 v21, v22, v22
v_sub_f32 v22, v15, v20
v_fmac_f32 v21, v22, v22
v_sub_f32 v22, v16, v20
v_fmac_f32 v21, v22, v22
v_sub_f32 v22, v17, v20
v_fmac_f32 v21, v22, v22
v_sub_f32 v22, v18, v20
v_fmac_f32 v21, v22, v22
v_sub_f32 v22, v19, v20
v_fmac_f32 v21, v22, v22
s_nop 1
v_add_f32_dpp v21, v21, v21 quad_perm:[1,0,3,2] row_mask:0xf bank_mask:0xf
s_nop 1
v_add_f32_dpp v21, v21, v21 quad_perm:[2,3,0,1] row_mask:0xf bank_mask:0xf
s_nop 1
v_add_f32_dpp v21, v21, v21 row_half_mirror row_mask:0xf bank_mask:0xf
s_nop 1
v_add_f32_dpp v21, v21, v21 row_mirror row_mask:0xf bank_mask:0xf
v_mov_b32 v22, v21
s_nop 1
v_permlane16_swap_b32 v21, v22
v_add_f32 v21, v21, v22
v_mov_b32 v22, v21
s_nop 1
v_permlane32_swap_b32 v21, v22
v_add_f32 v21, v21, v22
v_mul_f32 v21, 0x3b000000, v21
v_cvt_pk_bf16_f32 v20, v20, v20
v_lshlrev_b32 v20, 16, v20
v_cvt_pk_bf16_f32 v21, v21, v21
v_lshlrev_b32 v21, 16, v21
v_add_f32 v21, 0x3727c5ac, v21
v_cvt_pk_bf16_f32 v21, v21, v21
v_lshlrev_b32 v21, 16, v21
v_sqrt_f32 v21, v21
s_nop 0
v_cvt_pk_bf16_f32 v21, v21, v21
v_lshlrev_b32 v21, 16, v21
v_rcp_f32 v21, v21
v_sub_f32 v12, v12, v20
v_sub_f32 v13, v13, v20
v_sub_f32 v14, v14, v20
v_sub_f32 v15, v15, v20
v_sub_f32 v16, v16, v20
v_sub_f32 v17, v17, v20
v_sub_f32 v18, v18, v20
v_sub_f32 v19, v19, v20
v_cvt_pk_bf16_f32 v8, v12, v13
v_cvt_pk_bf16_f32 v9, v14, v15
v_cvt_pk_bf16_f32 v10, v16, v17
v_cvt_pk_bf16_f32 v11, v18, v19
v_lshlrev_b32 v12, 16, v8
v_and_b32 v13, 0xffff0000, v8
v_lshlrev_b32 v14, 16, v9
v_and_b32 v15, 0xffff0000, v9
v_lshlrev_b32 v16, 16, v10
v_and_b32 v17, 0xffff0000, v10
v_lshlrev_b32 v18, 16, v11
v_and_b32 v19, 0xffff0000, v11
v_mul_f32 v12, v12, v21
v_mul_f32 v13, v13, v21
v_mul_f32 v14, v14, v21
v_mul_f32 v15, v15, v21
v_mul_f32 v16, v16, v21
v_mul_f32 v17, v17, v21
v_mul_f32 v18, v18, v21
v_mul_f32 v19, v19, v21
v_cvt_pk_bf16_f32 v8, v12, v13
v_cvt_pk_bf16_f32 v9, v14, v15
v_cvt_pk_bf16_f32 v10, v16, v17
v_cvt_pk_bf16_f32 v11, v18, v19
ds_write_b128 v6, v[8:11] offset:0
v_mov_b32 v30, 0
s_waitcnt vmcnt(11) lgkmcnt(0)
s_cmp_eq_u32 s67, 1
s_cbranch_scc0 ic_3
s_waitcnt vmcnt(3)
ic_3:
s_add_u32 s63, s53, 0
buffer_load_dwordx4 v[64:67], v4, s[12:15], s63 offen
s_add_u32 s63, s53, 8192
buffer_load_dwordx4 v[68:71], v4, s[12:15], s63 offen
s_add_u32 s63, s53, 16384
buffer_load_dwordx4 v[72:75], v4, s[12:15], s63 offen
s_add_u32 s63, s53, 24576
buffer_load_dwordx4 v[76:79], v4, s[12:15], s63 offen
s_add_u32 s63, s53, 32768
buffer_load_dwordx4 v[80:83], v4, s[12:15], s63 offen
s_add_u32 s63, s53, 40960
buffer_load_dwordx4 v[84:87], v4, s[12:15], s63 offen
s_add_u32 s63, s53, 49152
buffer_load_dwordx4 v[88:91], v4, s[12:15], s63 offen
s_add_u32 s63, s53, 57344
buffer_load_dwordx4 v[92:95], v4, s[12:15], s63 offen
s_barrier
s_xor_b32 s63, s73, 0
s_lshl_b32 s63, s63, 6
v_add_u32 v6, s63, v7
ds_read_b128 v[8:11], v6 offset:0
s_xor_b32 s63, s73, 1
s_lshl_b32 s63, s63, 6
v_add_u32 v6, s63, v7
ds_read_b128 v[12:15], v6 offset:0
s_xor_b32 s63, s73, 2
s_lshl_b32 s63, s63, 6
v_add_u32 v6, s63, v7
ds_read_b128 v[16:19], v6 offset:0
s_xor_b32 s63, s73, 3
s_lshl_b32 s63, s63, 6
v_add_u32 v6, s63, v7
ds_read_b128 v[20:23], v6 offset:0
s_add_u32 s63, s54, 0
buffer_load_dwordx4 v[96:99], v4, s[12:15], s63 offen
s_add_u32 s63, s54, 8192
buffer_load_dwordx4 v[100:103], v4, s[12:15], s63 offen
s_add_u32 s63, s54, 16384
buffer_load_dwordx4 v[104:107], v4, s[12:15], s63 offen
s_add_u32 s63, s54, 24576
buffer_load_dwordx4 v[108:111], v4, s[12:15], s63 offen
s_add_u32 s63, s54, 32768
buffer_load_dwordx4 v[112:115], v4, s[12:15], s63 offen
s_add_u32 s63, s54, 40960
buffer_load_dwordx4 v[116:119], v4, s[12:15], s63 offen
s_add_u32 s63, s54, 49152
buffer_load_dwordx4 v[120:123], v4, s[12:15], s63 offen
s_add_u32 s63, s54, 57344
buffer_load_dwordx4 v[124:127], v4, s[12:15], s63 offen
s_mul_i32 s62, s3, 272
v_lshlrev_b32 v6, 4, v2
v_add_u32 v6, s62, v6
v_mul_u32_u24 v7, 272, v2
v_lshl_add_u32 v7, v3, 4, v7
s_waitcnt lgkmcnt(0)
v_perm_b32 v192, v36, v32, s60
v_perm_b32 v193, v44, v40, s60
v_perm_b32 v194, v52, v48, s60
v_perm_b32 v195, v60, v56, s60
v_perm_b32 v196, v36, v32, s61
v_perm_b32 v197, v44, v40, s61
v_perm_b32 v198, v52, v48, s61
v_perm_b32 v199, v60, v56, s61
v_mfma_f32_16x16x32_bf16 v[224:227], v[8:11], v[192:195], 0
v_perm_b32 v200, v37, v33, s60
v_perm_b32 v201, v45, v41, s60
v_perm_b32 v202, v53, v49, s60
v_perm_b32 v203, v61, v57, s60
v_mfma_f32_16x16x32_bf16 v[228:231], v[8:11], v[196:199], 0
v_perm_b32 v204, v37, v33, s61
v_perm_b32 v205, v45, v41, s61
v_perm_b32 v206, v53, v49, s61
v_perm_b32 v207, v61, v57, s61
v_mfma_f32_16x16x32_bf16 v[232:235], v[8:11], v[200:203], 0
v_perm_b32 v208, v38, v34, s60
v_perm_b32 v209, v46, v42, s60
v_perm_b32 v210, v54, v50, s60
v_perm_b32 v211, v62, v58, s60
v_mfma_f32_16x16x32_bf16 v[236:239], v[8:11], v[204:207], 0
v_perm_b32 v212, v38, v34, s61
v_perm_b32 v213, v46, v42, s61
v_perm_b32 v214, v54, v50, s61
v_perm_b32 v215, v62, v58, s61
v_mfma_f32_16x16x32_bf16 v[240:243], v[8:11], v[208:211], 0
v_perm_b32 v216, v39, v35, s60
v_perm_b32 v217, v47, v43, s60
v_perm_b32 v218, v55, v51, s60
v_perm_b32 v219, v63, v59, s60
v_mfma_f32_16x16x32_bf16 v[244:247], v[8:11], v[212:215], 0
v_perm_b32 v220, v39, v35, s61
v_perm_b32 v221, v47, v43, s61
v_perm_b32 v222, v55, v51, s61
v_perm_b32 v223, v63, v59, s61
v_mfma_f32_16x16x32_bf16 v[248:251], v[8:11], v[216:219], 0
s_nop 0
v_mfma_f32_16x16x32_bf16 v[252:255], v[8:11], v[220:223], 0
s_add_u32 s63, s55, 0
buffer_load_dwordx4 v[128:131], v4, s[12:15], s63 offen
s_add_u32 s63, s55, 8192
buffer_load_dwordx4 v[132:135], v4, s[12:15], s63 offen
s_add_u32 s63, s55, 16384
buffer_load_dwordx4 v[136:139], v4, s[12:15], s63 offen
s_add_u32 s63, s55, 24576
buffer_load_dwordx4 v[140:143], v4, s[12:15], s63 offen
s_add_u32 s63, s55, 32768
buffer_load_dwordx4 v[144:147], v4, s[12:15], s63 offen
s_add_u32 s63, s55, 40960
buffer_load_dwordx4 v[148:151], v4, s[12:15], s63 offen
s_add_u32 s63, s55, 49152
buffer_load_dwordx4 v[152:155], v4, s[12:15], s63 offen
s_add_u32 s63, s55, 57344
buffer_load_dwordx4 v[156:159], v4, s[12:15], s63 offen
s_waitcnt vmcnt(16)
v_perm_b32 v192, v68, v64, s60
v_perm_b32 v193, v76, v72, s60
v_perm_b32 v194, v84, v80, s60
v_perm_b32 v195, v92, v88, s60
v_perm_b32 v196, v68, v64, s61
v_perm_b32 v197, v76, v72, s61
v_perm_b32 v198, v84, v80, s61
v_perm_b32 v199, v92, v88, s61
v_mfma_f32_16x16x32_bf16 v[224:227], v[12:15], v[192:195], v[224:227]
v_perm_b32 v200, v69, v65, s60
v_perm_b32 v201, v77, v73, s60
v_perm_b32 v202, v85, v81, s60
v_perm_b32 v203, v93, v89, s60
v_mfma_f32_16x16x32_bf16 v[228:231], v[12:15], v[196:199], v[228:231]
v_perm_b32 v204, v69, v65, s61
v_perm_b32 v205, v77, v73, s61
v_perm_b32 v206, v85, v81, s61
v_perm_b32 v207, v93, v89, s61
v_mfma_f32_16x16x32_bf16 v[232:235], v[12:15], v[200:203], v[232:235]
v_perm_b32 v208, v70, v66, s60
v_perm_b32 v209, v78, v74, s60
v_perm_b32 v210, v86, v82, s60
v_perm_b32 v211, v94, v90, s60
v_mfma_f32_16x16x32_bf16 v[236:239], v[12:15], v[204:207], v[236:239]
v_perm_b32 v212, v70, v66, s61
v_perm_b32 v213, v78, v74, s61
v_perm_b32 v214, v86, v82, s61
v_perm_b32 v215, v94, v90, s61
v_mfma_f32_16x16x32_bf16 v[240:243], v[12:15], v[208:211], v[240:243]
v_perm_b32 v216, v71, v67, s60
v_perm_b32 v217, v79, v75, s60
v_perm_b32 v218, v87, v83, s60
v_perm_b32 v219, v95, v91, s60
v_mfma_f32_16x16x32_bf16 v[244:247], v[12:15], v[212:215], v[244:247]
v_perm_b32 v220, v71, v67, s61
v_perm_b32 v221, v79, v75, s61
v_perm_b32 v222, v87, v83, s61
v_perm_b32 v223, v95, v91, s61
v_mfma_f32_16x16x32_bf16 v[248:251], v[12:15], v[216:219], v[248:251]
s_nop 0
v_mfma_f32_16x16x32_bf16 v[252:255], v[12:15], v[220:223], v[252:255]
s_cmp_eq_u32 s67, 1
s_cbranch_scc0 ic_4
buffer_load_dwordx4 v[160:163], v5, s[44:47], s78 offen offset:0
buffer_load_dwordx4 v[164:167], v5, s[44:47], s78 offen offset:64
buffer_load_dwordx4 v[168:171], v5, s[44:47], s78 offen offset:128
buffer_load_dwordx4 v[172:175], v5, s[44:47], s78 offen offset:192
buffer_load_dwordx4 v[176:179], v5, s[44:47], s79 offen offset:0
buffer_load_dwordx4 v[180:183], v5, s[44:47], s79 offen offset:64
buffer_load_dwordx4 v[184:187], v5, s[44:47], s79 offen offset:128
buffer_load_dwordx4 v[188:191], v5, s[44:47], s79 offen offset:192
ic_4:
s_waitcnt vmcnt(16)
s_cmp_eq_u32 s67, 1
s_cbranch_scc1 ic_5
s_waitcnt vmcnt(8)
ic_5:
buffer_load_dword v31, v30, s[8:11], 0 offen sc1
v_perm_b32 v192, v100, v96, s60
v_perm_b32 v193, v108, v104, s60
v_perm_b32 v194, v116, v112, s60
v_perm_b32 v195, v124, v120, s60
v_perm_b32 v196, v100, v96, s61
v_perm_b32 v197, v108, v104, s61
v_perm_b32 v198, v116, v112, s61
v_perm_b32 v199, v124, v120, s61
v_mfma_f32_16x16x32_bf16 v[224:227], v[16:19], v[192:195], v[224:227]
v_perm_b32 v200, v101, v97, s60
v_perm_b32 v201, v109, v105, s60
v_perm_b32 v202, v117, v113, s60
v_perm_b32 v203, v125, v121, s60
v_mfma_f32_16x16x32_bf16 v[228:231], v[16:19], v[196:199], v[228:231]
v_perm_b32 v204, v101, v97, s61
v_perm_b32 v205, v109, v105, s61
v_perm_b32 v206, v117, v113, s61
v_perm_b32 v207, v125, v121, s61
v_mfma_f32_16x16x32_bf16 v[232:235], v[16:19], v[200:203], v[232:235]
v_perm_b32 v208, v102, v98, s60
v_perm_b32 v209, v110, v106, s60
v_perm_b32 v210, v118, v114, s60
v_perm_b32 v211, v126, v122, s60
v_mfma_f32_16x16x32_bf16 v[236:239], v[16:19], v[204:207], v[236:239]
v_perm_b32 v212, v102, v98, s61
v_perm_b32 v213, v110, v106, s61
v_perm_b32 v214, v118, v114, s61
v_perm_b32 v215, v126, v122, s61
v_mfma_f32_16x16x32_bf16 v[240:243], v[16:19], v[208:211], v[240:243]
v_perm_b32 v216, v103, v99, s60
v_perm_b32 v217, v111, v107, s60
v_perm_b32 v218, v119, v115, s60
v_perm_b32 v219, v127, v123, s60
v_mfma_f32_16x16x32_bf16 v[244:247], v[16:19], v[212:215], v[244:247]
v_perm_b32 v220, v103, v99, s61
v_perm_b32 v221, v111, v107, s61
v_perm_b32 v222, v119, v115, s61
v_perm_b32 v223, v127, v123, s61
v_mfma_f32_16x16x32_bf16 v[248:251], v[16:19], v[216:219], v[248:251]
s_nop 0
v_mfma_f32_16x16x32_bf16 v[252:255], v[16:19], v[220:223], v[252:255]
s_waitcnt vmcnt(9)
s_cmp_eq_u32 s67, 1
s_cbranch_scc1 ic_6
s_waitcnt vmcnt(1)
ic_6:
v_perm_b32 v192, v132, v128, s60
v_perm_b32 v193, v140, v136, s60
v_perm_b32 v194, v148, v144, s60
v_perm_b32 v195, v156, v152, s60
v_perm_b32 v196, v132, v128, s61
v_perm_b32 v197, v140, v136, s61
v_perm_b32 v198, v148, v144, s61
v_perm_b32 v199, v156, v152, s61
v_mfma_f32_16x16x32_bf16 v[224:227], v[20:23], v[192:195], v[224:227]
v_perm_b32 v200, v133, v129, s60
v_perm_b32 v201, v141, v137, s60
v_perm_b32 v202, v149, v145, s60
v_perm_b32 v203, v157, v153, s60
v_mfma_f32_16x16x32_bf16 v[228:231], v[20:23], v[196:199], v[228:231]
v_perm_b32 v204, v133, v129, s61
v_perm_b32 v205, v141, v137, s61
v_perm_b32 v206, v149, v145, s61
v_perm_b32 v207, v157, v153, s61
v_mfma_f32_16x16x32_bf16 v[232:235], v[20:23], v[200:203], v[232:235]
v_perm_b32 v208, v134, v130, s60
v_perm_b32 v209, v142, v138, s60
v_perm_b32 v210, v150, v146, s60
v_perm_b32 v211, v158, v154, s60
v_mfma_f32_16x16x32_bf16 v[236:239], v[20:23], v[204:207], v[236:239]
v_perm_b32 v212, v134, v130, s61
v_perm_b32 v213, v142, v138, s61
v_perm_b32 v214, v150, v146, s61
v_perm_b32 v215, v158, v154, s61
v_mfma_f32_16x16x32_bf16 v[240:243], v[20:23], v[208:211], v[240:243]
v_perm_b32 v216, v135, v131, s60
v_perm_b32 v217, v143, v139, s60
v_perm_b32 v218, v151, v147, s60
v_perm_b32 v219, v159, v155, s60
v_mfma_f32_16x16x32_bf16 v[244:247], v[20:23], v[212:215], v[244:247]
v_perm_b32 v220, v135, v131, s61
v_perm_b32 v221, v143, v139, s61
v_perm_b32 v222, v151, v147, s61
v_perm_b32 v223, v159, v155, s61
v_mfma_f32_16x16x32_bf16 v[248:251], v[20:23], v[216:219], v[248:251]
s_nop 0
v_mfma_f32_16x16x32_bf16 v[252:255], v[20:23], v[220:223], v[252:255]
v_cvt_pk_bf16_f32 v8, v224, v228
v_cvt_pk_bf16_f32 v12, v225, v229
v_cvt_pk_bf16_f32 v16, v226, v230
v_cvt_pk_bf16_f32 v20, v227, v231
v_cvt_pk_bf16_f32 v9, v232, v236
v_cvt_pk_bf16_f32 v13, v233, v237
v_cvt_pk_bf16_f32 v17, v234, v238
v_cvt_pk_bf16_f32 v21, v235, v239
v_cvt_pk_bf16_f32 v10, v240, v244
v_cvt_pk_bf16_f32 v14, v241, v245
v_cvt_pk_bf16_f32 v18, v242, v246
v_cvt_pk_bf16_f32 v22, v243, v247
v_cvt_pk_bf16_f32 v11, v248, v252
v_cvt_pk_bf16_f32 v15, v249, v253
v_cvt_pk_bf16_f32 v19, v250, v254
v_cvt_pk_bf16_f32 v23, v251, v255
s_mov_b64 exec, 0xffff
ds_write_b128 v6, v[8:11] offset:8192
ds_write_b128 v6, v[12:15] offset:9280
ds_write_b128 v6, v[16:19] offset:10368
ds_write_b128 v6, v[20:23] offset:11456
s_mov_b64 exec, -1
s_waitcnt lgkmcnt(0)
s_barrier
ds_read_b128 v[8:11], v7 offset:8192
ds_read_b128 v[12:15], v7 offset:8256
ds_read_b128 v[16:19], v7 offset:8320
ds_read_b128 v[20:23], v7 offset:8384
s_waitcnt vmcnt(1)
s_waitcnt lgkmcnt(3)
v_mfma_f32_16x16x32_bf16 v[224:227], v[8:11], v[160:163], 0
v_mfma_f32_16x16x32_bf16 v[228:231], v[8:11], v[176:179], 0
s_waitcnt lgkmcnt(2)
v_mfma_f32_16x16x32_bf16 v[224:227], v[12:15], v[164:167], v[224:227]
v_mfma_f32_16x16x32_bf16 v[228:231], v[12:15], v[180:183], v[228:231]
s_waitcnt lgkmcnt(1)
v_mfma_f32_16x16x32_bf16 v[224:227], v[16:19], v[168:171], v[224:227]
v_mfma_f32_16x16x32_bf16 v[228:231], v[16:19], v[184:187], v[228:231]
s_waitcnt lgkmcnt(0)
v_mfma_f32_16x16x32_bf16 v[224:227], v[20:23], v[172:175], v[224:227]
v_mfma_f32_16x16x32_bf16 v[228:231], v[20:23], v[188:191], v[228:231]
s_waitcnt vmcnt(0)
v_cmp_ne_u32 vcc, 16, v31
s_mov_b32 s12, s18
s_and_b32 s13, s19, 0xffff
s_mov_b32 s14, 33554432
s_mov_b32 s15, 0x20000
v_lshlrev_b32 v4, 7, v1
s_lshr_b32 s62, s42, 5
v_add_f32 v224, v224, v225
v_add_f32 v226, v226, v227
v_add_f32 v228, v228, v229
v_add_f32 v230, v230, v231
v_add_f32 v224, v224, v226
v_add_f32 v228, v228, v230
v_mul_f32 v224, 0x3e0293ee, v224
v_mul_f32 v228, 0x3e0293ee, v228
v_cvt_pk_bf16_f32 v8, v224, v228
s_cbranch_vccz L_T_c0ok
s_mov_b32 s64, 100000
s_branch plf_9
pl_7:
s_sleep 4
plf_9:
buffer_load_dword v31, v30, s[8:11], 0 offen sc1
s_sub_u32 s64, s64, 1
s_cmp_eq_u32 s64, 0
s_waitcnt vmcnt(0)
s_cbranch_scc1 ple_8
v_cmp_ne_u32 vcc, 16, v31
s_cbranch_vccnz pl_7
ple_8:
L_T_c0ok:
buffer_store_dword v8, v28, s[4:7], s74 offen sc1
s_barrier
s_lshl_b32 s62, s62, 23
s_and_b32 s63, s42, 31
s_lshl_b32 s63, s63, 15
s_add_u32 s62, s62, s63
s_lshl_b32 s63, s3, 13
s_add_u32 s62, s62, s63
s_add_u32 s63, s62, 393216
s_and_b32 s63, s63, 0xfffff
s_andn2_b32 s64, s62, 0xfffff
s_or_b32 s63, s63, s64
s_add_u32 s63, s63, 4194304
buffer_load_dword v31, v4, s[12:15], s63 offen
s_add_u32 s63, s62, 753664
s_and_b32 s63, s63, 0xfffff
s_andn2_b32 s64, s62, 0xfffff
s_or_b32 s63, s63, s64
s_add_u32 s63, s63, 5242880
buffer_load_dword v31, v4, s[12:15], s63 offen
s_add_u32 s63, s62, 65536
s_and_b32 s63, s63, 0xfffff
s_andn2_b32 s64, s62, 0xfffff
s_or_b32 s63, s63, s64
s_add_u32 s63, s63, 6291456
buffer_load_dword v31, v4, s[12:15], s63 offen
s_add_u32 s63, s62, 425984
s_and_b32 s63, s63, 0xfffff
s_andn2_b32 s64, s62, 0xfffff
s_or_b32 s63, s63, s64
s_add_u32 s63, s63, 7340032
buffer_load_dword v31, v4, s[12:15], s63 offen
s_mov_b32 s12, s24
s_and_b32 s13, s25, 0xffff
s_mov_b32 s14, 4194304
s_mov_b32 s15, 0x20000
s_mov_b32 s44, s26
s_and_b32 s45, s27, 0xffff
s_mov_b32 s46, 4194304
s_mov_b32 s47, 0x20000
s_xor_b32 s63, s73, 0
s_lshr_b32 s62, s63, 1
s_lshl_b32 s62, s62, 19
s_and_b32 s63, s63, 1
s_lshl_b32 s63, s63, 16
s_add_u32 s52, s66, s62
s_add_u32 s52, s52, s63
s_xor_b32 s63, s73, 1
s_lshr_b32 s62, s63, 1
s_lshl_b32 s62, s62, 19
s_and_b32 s63, s63, 1
s_lshl_b32 s63, s63, 16
s_add_u32 s53, s66, s62
s_add_u32 s53, s53, s63
s_xor_b32 s63, s73, 2
s_lshr_b32 s62, s63, 1
s_lshl_b32 s62, s62, 19
s_and_b32 s63, s63, 1
s_lshl_b32 s63, s63, 16
s_add_u32 s54, s66, s62
s_add_u32 s54, s54, s63
s_xor_b32 s63, s73, 3
s_lshr_b32 s62, s63, 1
s_lshl_b32 s62, s62, 19
s_and_b32 s63, s63, 1
s_lshl_b32 s63, s63, 16
s_add_u32 s55, s66, s62
s_add_u32 s55, s55, s63
v_and_b32 v6, 1, v3
v_lshrrev_b32 v7, 1, v3
v_lshlrev_b32 v4, 18, v6
v_lshl_add_u32 v4, v7, 15, v4
v_lshl_add_u32 v4, v2, 4, v4
v_lshlrev_b32 v5, 14, v7
v_lshl_add_u32 v5, v6, 12, v5
v_lshl_add_u32 v5, v2, 4, v5
s_lshl_b32 s79, s72, 17
s_lshl_b32 s63, s3, 8
s_add_u32 s79, s79, s63
s_add_u32 s63, s52, 0
buffer_load_dwordx4 v[192:195], v4, s[12:15], s63 offen
s_add_u32 s63, s52, 8192
buffer_load_dwordx4 v[196:199], v4, s[12:15], s63 offen
s_add_u32 s63, s52, 16384
buffer_load_dwordx4 v[200:203], v4, s[12:15], s63 offen
s_add_u32 s63, s52, 24576
buffer_load_dwordx4 v[204:207], v4, s[12:15], s63 offen
s_add_u32 s63, s52, 131072
buffer_load_dwordx4 v[208:211], v4, s[12:15], s63 offen
s_add_u32 s63, s52, 139264
buffer_load_dwordx4 v[212:215], v4, s[12:15], s63 offen
s_add_u32 s63, s52, 147456
buffer_load_dwordx4 v[216:219], v4, s[12:15], s63 offen
s_add_u32 s63, s52, 155648
buffer_load_dwordx4 v[220:223], v4, s[12:15], s63 offen
s_xor_b32 s62, s73, 0
s_lshl_b32 s62, s62, 15
s_add_u32 s62, s62, s79
s_add_u32 s63, s62, 0x2000
buffer_load_dwordx4 v[224:227], v5, s[44:47], s62 offen offset:0
buffer_load_dwordx4 v[228:231], v5, s[44:47], s62 offen offset:1024
buffer_load_dwordx4 v[232:235], v5, s[44:47], s63 offen offset:0
buffer_load_dwordx4 v[236:239], v5, s[44:47], s63 offen offset:1024
buffer_load_dwordx4 v[240:243], v5, s[44:47], s62 offen offset:2048
buffer_load_dwordx4 v[244:247], v5, s[44:47], s62 offen offset:3072
buffer_load_dwordx4 v[248:251], v5, s[44:47], s63 offen offset:2048
buffer_load_dwordx4 v[252:255], v5, s[44:47], s63 offen offset:3072
v_lshlrev_b32 v8, 1, v3
v_xor_b32 v8, v8, v2
v_lshlrev_b32 v8, 4, v8
v_lshl_add_u32 v8, v3, 10, v8
v_xor_b32 v9, 0x80, v8
s_lshl_b32 s68, s3, 13
s_add_u32 s68, s68, 16384
v_bfe_u32 v11, v1, 2, 2
v_lshl_add_u32 v10, v3, 3, v11
v_lshlrev_b32 v10, 8, v10
v_and_b32 v12, 1, v3
v_lshl_add_u32 v12, v12, 2, v11
v_lshlrev_b32 v12, 1, v12
v_bfe_u32 v13, v1, 1, 1
v_xor_b32 v12, v12, v13
v_lshl_add_u32 v10, v12, 4, v10
v_and_b32 v13, 1, v1
v_lshl_add_u32 v10, v13, 3, v10
v_add_u32 v10, s68, v10
s_lshr_b32 s63, s73, 1
s_lshl_b32 s63, s63, 7
s_and_b32 s62, s73, 1
s_lshl_b32 s62, s62, 4
s_or_b32 s63, s63, s62
v_xor_b32 v10, s63, v10
v_xor_b32 v112, 0, v10
v_xor_b32 v113, 32, v10
v_xor_b32 v114, 64, v10
v_xor_b32 v115, 96, v10
v_xor_b32 v116, 128, v10
v_xor_b32 v117, 160, v10
v_xor_b32 v118, 192, v10
v_xor_b32 v119, 224, v10
s_mov_b32 s70, 0xaaaaaaaa
s_mov_b32 s71, 0xaaaaaaaa
v_mov_b32 v29, 0x4444
v_mov_b32 v28, 0xeeee
v_cndmask_b32 v29, v29, v28, s[70:71]
s_lshl_b32 s69, s75, 15
s_lshl_b32 s63, s3, 8
s_add_u32 s69, s69, s63
s_add_u32 s69, s69, 1048576
v_and_b32 v13, 31, v1
v_lshlrev_b32 v14, 7, v13
s_lshl_b32 s62, s3, 6
v_lshlrev_b32 v13, 1, v13
v_add_u32 v13, s62, v13
v_lshlrev_b32 v15, 4, v3
v_add_u32 v15, s62, v15
s_mul_i32 s62, s3, 272
v_lshlrev_b32 v120, 4, v2
v_add_u32 v121, s62, v120
v_bfe_u32 v10, v2, 2, 1
v_lshlrev_b32 v11, 5, v3
v_lshl_add_u32 v11, v10, 4, v11
s_lshl_b32 s62, s73, 6
v_xor_b32 v11, s62, v11
v_xor_b32 v12, 0x80, v11
v_and_b32 v122, 3, v2
v_mul_u32_u24 v122, 272, v122
v_add_u32 v123, v122, v12
v_add_u32 v122, v122, v11
v_mul_u32_u24 v30, 0xaaaa, v10
v_or_b32 v30, 0x4444, v30
v_lshl_add_u32 v120, v6, 3, v120
s_lshl_b32 s78, s75, 10
s_lshl_b32 s63, s3, 8
s_add_u32 s78, s78, s63
s_add_u32 s78, s78, 5242880
v_mov_b32 v128, 0
v_mov_b32 v129, 0
v_mov_b32 v130, 0
v_mov_b32 v131, 0
v_mov_b32 v132, 0
v_mov_b32 v133, 0
v_mov_b32 v134, 0
v_mov_b32 v135, 0
v_mov_b32 v136, 0
v_mov_b32 v137, 0
v_mov_b32 v138, 0
v_mov_b32 v139, 0
v_mov_b32 v140, 0
v_mov_b32 v141, 0
v_mov_b32 v142, 0
v_mov_b32 v143, 0
v_mov_b32 v144, 0
v_mov_b32 v145, 0
v_mov_b32 v146, 0
v_mov_b32 v147, 0
v_mov_b32 v148, 0
v_mov_b32 v149, 0
v_mov_b32 v150, 0
v_mov_b32 v151, 0
v_mov_b32 v152, 0
v_mov_b32 v153, 0
v_mov_b32 v154, 0
v_mov_b32 v155, 0
v_mov_b32 v156, 0
v_mov_b32 v157, 0
v_mov_b32 v158, 0
v_mov_b32 v159, 0
v_mov_b32 v160, 0
v_mov_b32 v161, 0
v_mov_b32 v162, 0
v_mov_b32 v163, 0
v_mov_b32 v164, 0
v_mov_b32 v165, 0
v_mov_b32 v166, 0
v_mov_b32 v167, 0
v_mov_b32 v168, 0
v_mov_b32 v169, 0
v_mov_b32 v170, 0
v_mov_b32 v171, 0
v_mov_b32 v172, 0
v_mov_b32 v173, 0
v_mov_b32 v174, 0
v_mov_b32 v175, 0
v_mov_b32 v176, 0
v_mov_b32 v177, 0
v_mov_b32 v178, 0
v_mov_b32 v179, 0
v_mov_b32 v180, 0
v_mov_b32 v181, 0
v_mov_b32 v182, 0
v_mov_b32 v183, 0
v_mov_b32 v184, 0
v_mov_b32 v185, 0
v_mov_b32 v186, 0
v_mov_b32 v187, 0
v_mov_b32 v188, 0
v_mov_b32 v189, 0
v_mov_b32 v190, 0
v_mov_b32 v191, 0
s_waitcnt vmcnt(8)
v_perm_b32 v16, v196, v192, s60
v_perm_b32 v17, v204, v200, s60
v_perm_b32 v18, v212, v208, s60
v_perm_b32 v19, v220, v216, s60
v_accvgpr_write_b32 a0, v16
v_accvgpr_write_b32 a1, v17
v_accvgpr_write_b32 a2, v18
v_accvgpr_write_b32 a3, v19
v_perm_b32 v20, v196, v192, s61
v_perm_b32 v21, v204, v200, s61
v_perm_b32 v22, v212, v208, s61
v_perm_b32 v23, v220, v216, s61
v_accvgpr_write_b32 a8, v20
v_accvgpr_write_b32 a9, v21
v_accvgpr_write_b32 a10, v22
v_accvgpr_write_b32 a11, v23
v_perm_b32 v16, v197, v193, s60
v_perm_b32 v17, v205, v201, s60
v_perm_b32 v18, v213, v209, s60
v_perm_b32 v19, v221, v217, s60
v_accvgpr_write_b32 a16, v16
v_accvgpr_write_b32 a17, v17
v_accvgpr_write_b32 a18, v18
v_accvgpr_write_b32 a19, v19
v_perm_b32 v20, v197, v193, s61
v_perm_b32 v21, v205, v201, s61
v_perm_b32 v22, v213, v209, s61
v_perm_b32 v23, v221, v217, s61
v_accvgpr_write_b32 a24, v20
v_accvgpr_write_b32 a25, v21
v_accvgpr_write_b32 a26, v22
v_accvgpr_write_b32 a27, v23
v_perm_b32 v16, v198, v194, s60
v_perm_b32 v17, v206, v202, s60
v_perm_b32 v18, v214, v210, s60
v_perm_b32 v19, v222, v218, s60
v_accvgpr_write_b32 a32, v16
v_accvgpr_write_b32 a33, v17
v_accvgpr_write_b32 a34, v18
v_accvgpr_write_b32 a35, v19
v_perm_b32 v20, v198, v194, s61
v_perm_b32 v21, v206, v202, s61
v_perm_b32 v22, v214, v210, s61
v_perm_b32 v23, v222, v218, s61
v_accvgpr_write_b32 a40, v20
v_accvgpr_write_b32 a41, v21
v_accvgpr_write_b32 a42, v22
v_accvgpr_write_b32 a43, v23
v_perm_b32 v16, v199, v195, s60
v_perm_b32 v17, v207, v203, s60
v_perm_b32 v18, v215, v211, s60
v_perm_b32 v19, v223, v219, s60
v_accvgpr_write_b32 a48, v16
v_accvgpr_write_b32 a49, v17
v_accvgpr_write_b32 a50, v18
v_accvgpr_write_b32 a51, v19
v_perm_b32 v20, v199, v195, s61
v_perm_b32 v21, v207, v203, s61
v_perm_b32 v22, v215, v211, s61
v_perm_b32 v23, v223, v219, s61
v_accvgpr_write_b32 a56, v20
v_accvgpr_write_b32 a57, v21
v_accvgpr_write_b32 a58, v22
v_accvgpr_write_b32 a59, v23
s_waitcnt vmcnt(0)
s_xor_b32 s62, s73, 1
s_lshl_b32 s62, s62, 15
s_add_u32 s62, s62, s79
s_add_u32 s63, s62, 0x2000
buffer_load_dwordx4 v[64:67], v5, s[44:47], s62 offen offset:0
buffer_load_dwordx4 v[68:71], v5, s[44:47], s62 offen offset:1024
buffer_load_dwordx4 v[72:75], v5, s[44:47], s63 offen offset:0
buffer_load_dwordx4 v[76:79], v5, s[44:47], s63 offen offset:1024
buffer_load_dwordx4 v[80:83], v5, s[44:47], s62 offen offset:2048
buffer_load_dwordx4 v[84:87], v5, s[44:47], s62 offen offset:3072
buffer_load_dwordx4 v[88:91], v5, s[44:47], s63 offen offset:2048
buffer_load_dwordx4 v[92:95], v5, s[44:47], s63 offen offset:3072
s_xor_b32 s62, s73, 2
s_lshl_b32 s62, s62, 15
s_add_u32 s62, s62, s79
s_add_u32 s63, s62, 0x2000
buffer_load_dwordx4 v[192:195], v5, s[44:47], s62 offen offset:0
buffer_load_dwordx4 v[196:199], v5, s[44:47], s62 offen offset:1024
buffer_load_dwordx4 v[200:203], v5, s[44:47], s63 offen offset:0
buffer_load_dwordx4 v[204:207], v5, s[44:47], s63 offen offset:1024
buffer_load_dwordx4 v[208:211], v5, s[44:47], s62 offen offset:2048
buffer_load_dwordx4 v[212:215], v5, s[44:47], s62 offen offset:3072
buffer_load_dwordx4 v[216:219], v5, s[44:47], s63 offen offset:2048
buffer_load_dwordx4 v[220:223], v5, s[44:47], s63 offen offset:3072
v_perm_b32 v16, v228, v224, s60
v_perm_b32 v17, v236, v232, s60
v_perm_b32 v18, v244, v240, s60
v_perm_b32 v19, v252, v248, s60
v_accvgpr_write_b32 a128, v16
v_accvgpr_write_b32 a129, v17
v_accvgpr_write_b32 a130, v18
v_accvgpr_write_b32 a131, v19
v_perm_b32 v20, v228, v224, s61
v_perm_b32 v21, v236, v232, s61
v_perm_b32 v22, v244, v240, s61
v_perm_b32 v23, v252, v248, s61
v_accvgpr_write_b32 a136, v20
v_accvgpr_write_b32 a137, v21
v_accvgpr_write_b32 a138, v22
v_accvgpr_write_b32 a139, v23
v_perm_b32 v16, v229, v225, s60
v_perm_b32 v17, v237, v233, s60
v_perm_b32 v18, v245, v241, s60
v_perm_b32 v19, v253, v249, s60
v_accvgpr_write_b32 a144, v16
v_accvgpr_write_b32 a145, v17
v_accvgpr_write_b32 a146, v18
v_accvgpr_write_b32 a147, v19
v_perm_b32 v20, v229, v225, s61
v_perm_b32 v21, v237, v233, s61
v_perm_b32 v22, v245, v241, s61
v_perm_b32 v23, v253, v249, s61
v_accvgpr_write_b32 a152, v20
v_accvgpr_write_b32 a153, v21
v_accvgpr_write_b32 a154, v22
v_accvgpr_write_b32 a155, v23
v_perm_b32 v16, v230, v226, s60
v_perm_b32 v17, v238, v234, s60
v_perm_b32 v18, v246, v242, s60
v_perm_b32 v19, v254, v250, s60
v_accvgpr_write_b32 a160, v16
v_accvgpr_write_b32 a161, v17
v_accvgpr_write_b32 a162, v18
v_accvgpr_write_b32 a163, v19
v_perm_b32 v20, v230, v226, s61
v_perm_b32 v21, v238, v234, s61
v_perm_b32 v22, v246, v242, s61
v_perm_b32 v23, v254, v250, s61
v_accvgpr_write_b32 a168, v20
v_accvgpr_write_b32 a169, v21
v_accvgpr_write_b32 a170, v22
v_accvgpr_write_b32 a171, v23
v_perm_b32 v16, v231, v227, s60
v_perm_b32 v17, v239, v235, s60
v_perm_b32 v18, v247, v243, s60
v_perm_b32 v19, v255, v251, s60
v_accvgpr_write_b32 a176, v16
v_accvgpr_write_b32 a177, v17
v_accvgpr_write_b32 a178, v18
v_accvgpr_write_b32 a179, v19
v_perm_b32 v20, v231, v227, s61
v_perm_b32 v21, v239, v235, s61
v_perm_b32 v22, v247, v243, s61
v_perm_b32 v23, v255, v251, s61
v_accvgpr_write_b32 a184, v20
v_accvgpr_write_b32 a185, v21
v_accvgpr_write_b32 a186, v22
v_accvgpr_write_b32 a187, v23
s_waitcnt vmcnt(8)
s_xor_b32 s62, s73, 3
s_lshl_b32 s62, s62, 15
s_add_u32 s62, s62, s79
s_add_u32 s63, s62, 0x2000
buffer_load_dwordx4 v[224:227], v5, s[44:47], s62 offen offset:0
buffer_load_dwordx4 v[228:231], v5, s[44:47], s62 offen offset:1024
buffer_load_dwordx4 v[232:235], v5, s[44:47], s63 offen offset:0
buffer_load_dwordx4 v[236:239], v5, s[44:47], s63 offen offset:1024
buffer_load_dwordx4 v[240:243], v5, s[44:47], s62 offen offset:2048
buffer_load_dwordx4 v[244:247], v5, s[44:47], s62 offen offset:3072
buffer_load_dwordx4 v[248:251], v5, s[44:47], s63 offen offset:2048
buffer_load_dwordx4 v[252:255], v5, s[44:47], s63 offen offset:3072
v_perm_b32 v16, v68, v64, s60
v_perm_b32 v17, v76, v72, s60
v_perm_b32 v18, v84, v80, s60
v_perm_b32 v19, v92, v88, s60
v_accvgpr_write_b32 a132, v16
v_accvgpr_write_b32 a133, v17
v_accvgpr_write_b32 a134, v18
v_accvgpr_write_b32 a135, v19
v_perm_b32 v20, v68, v64, s61
v_perm_b32 v21, v76, v72, s61
v_perm_b32 v22, v84, v80, s61
v_perm_b32 v23, v92, v88, s61
v_accvgpr_write_b32 a140, v20
v_accvgpr_write_b32 a141, v21
v_accvgpr_write_b32 a142, v22
v_accvgpr_write_b32 a143, v23
v_perm_b32 v16, v69, v65, s60
v_perm_b32 v17, v77, v73, s60
v_perm_b32 v18, v85, v81, s60
v_perm_b32 v19, v93, v89, s60
v_accvgpr_write_b32 a148, v16
v_accvgpr_write_b32 a149, v17
v_accvgpr_write_b32 a150, v18
v_accvgpr_write_b32 a151, v19
v_perm_b32 v20, v69, v65, s61
v_perm_b32 v21, v77, v73, s61
v_perm_b32 v22, v85, v81, s61
v_perm_b32 v23, v93, v89, s61
v_accvgpr_write_b32 a156, v20
v_accvgpr_write_b32 a157, v21
v_accvgpr_write_b32 a158, v22
v_accvgpr_write_b32 a159, v23
v_perm_b32 v16, v70, v66, s60
v_perm_b32 v17, v78, v74, s60
v_perm_b32 v18, v86, v82, s60
v_perm_b32 v19, v94, v90, s60
v_accvgpr_write_b32 a164, v16
v_accvgpr_write_b32 a165, v17
v_accvgpr_write_b32 a166, v18
v_accvgpr_write_b32 a167, v19
v_perm_b32 v20, v70, v66, s61
v_perm_b32 v21, v78, v74, s61
v_perm_b32 v22, v86, v82, s61
v_perm_b32 v23, v94, v90, s61
v_accvgpr_write_b32 a172, v20
v_accvgpr_write_b32 a173, v21
v_accvgpr_write_b32 a174, v22
v_accvgpr_write_b32 a175, v23
v_perm_b32 v16, v71, v67, s60
v_perm_b32 v17, v79, v75, s60
v_perm_b32 v18, v87, v83, s60
v_perm_b32 v19, v95, v91, s60
v_accvgpr_write_b32 a180, v16
v_accvgpr_write_b32 a181, v17
v_accvgpr_write_b32 a182, v18
v_accvgpr_write_b32 a183, v19
v_perm_b32 v20, v71, v67, s61
v_perm_b32 v21, v79, v75, s61
v_perm_b32 v22, v87, v83, s61
v_perm_b32 v23, v95, v91, s61
v_accvgpr_write_b32 a188, v20
v_accvgpr_write_b32 a189, v21
v_accvgpr_write_b32 a190, v22
v_accvgpr_write_b32 a191, v23
s_waitcnt vmcnt(8)
s_add_u32 s63, s53, 0
buffer_load_dwordx4 v[64:67], v4, s[12:15], s63 offen
s_add_u32 s63, s53, 8192
buffer_load_dwordx4 v[68:71], v4, s[12:15], s63 offen
s_add_u32 s63, s53, 16384
buffer_load_dwordx4 v[72:75], v4, s[12:15], s63 offen
s_add_u32 s63, s53, 24576
buffer_load_dwordx4 v[76:79], v4, s[12:15], s63 offen
s_add_u32 s63, s53, 131072
buffer_load_dwordx4 v[80:83], v4, s[12:15], s63 offen
s_add_u32 s63, s53, 139264
buffer_load_dwordx4 v[84:87], v4, s[12:15], s63 offen
s_add_u32 s63, s53, 147456
buffer_load_dwordx4 v[88:91], v4, s[12:15], s63 offen
s_add_u32 s63, s53, 155648
buffer_load_dwordx4 v[92:95], v4, s[12:15], s63 offen
v_perm_b32 v16, v196, v192, s60
v_perm_b32 v17, v204, v200, s60
v_perm_b32 v18, v212, v208, s60
v_perm_b32 v19, v220, v216, s60
v_accvgpr_write_b32 a192, v16
v_accvgpr_write_b32 a193, v17
v_accvgpr_write_b32 a194, v18
v_accvgpr_write_b32 a195, v19
v_perm_b32 v20, v196, v192, s61
v_perm_b32 v21, v204, v200, s61
v_perm_b32 v22, v212, v208, s61
v_perm_b32 v23, v220, v216, s61
v_accvgpr_write_b32 a200, v20
v_accvgpr_write_b32 a201, v21
v_accvgpr_write_b32 a202, v22
v_accvgpr_write_b32 a203, v23
v_perm_b32 v16, v197, v193, s60
v_perm_b32 v17, v205, v201, s60
v_perm_b32 v18, v213, v209, s60
v_perm_b32 v19, v221, v217, s60
v_accvgpr_write_b32 a208, v16
v_accvgpr_write_b32 a209, v17
v_accvgpr_write_b32 a210, v18
v_accvgpr_write_b32 a211, v19
v_perm_b32 v20, v197, v193, s61
v_perm_b32 v21, v205, v201, s61
v_perm_b32 v22, v213, v209, s61
v_perm_b32 v23, v221, v217, s61
v_accvgpr_write_b32 a216, v20
v_accvgpr_write_b32 a217, v21
v_accvgpr_write_b32 a218, v22
v_accvgpr_write_b32 a219, v23
v_perm_b32 v16, v198, v194, s60
v_perm_b32 v17, v206, v202, s60
v_perm_b32 v18, v214, v210, s60
v_perm_b32 v19, v222, v218, s60
v_accvgpr_write_b32 a224, v16
v_accvgpr_write_b32 a225, v17
v_accvgpr_write_b32 a226, v18
v_accvgpr_write_b32 a227, v19
v_perm_b32 v20, v198, v194, s61
v_perm_b32 v21, v206, v202, s61
v_perm_b32 v22, v214, v210, s61
v_perm_b32 v23, v222, v218, s61
v_accvgpr_write_b32 a232, v20
v_accvgpr_write_b32 a233, v21
v_accvgpr_write_b32 a234, v22
v_accvgpr_write_b32 a235, v23
v_perm_b32 v16, v199, v195, s60
v_perm_b32 v17, v207, v203, s60
v_perm_b32 v18, v215, v211, s60
v_perm_b32 v19, v223, v219, s60
v_accvgpr_write_b32 a240, v16
v_accvgpr_write_b32 a241, v17
v_accvgpr_write_b32 a242, v18
v_accvgpr_write_b32 a243, v19
v_perm_b32 v20, v199, v195, s61
v_perm_b32 v21, v207, v203, s61
v_perm_b32 v22, v215, v211, s61
v_perm_b32 v23, v223, v219, s61
v_accvgpr_write_b32 a248, v20
v_accvgpr_write_b32 a249, v21
v_accvgpr_write_b32 a250, v22
v_accvgpr_write_b32 a251, v23
s_waitcnt vmcnt(8)
s_add_u32 s63, s54, 0
buffer_load_dwordx4 v[192:195], v4, s[12:15], s63 offen
s_add_u32 s63, s54, 8192
buffer_load_dwordx4 v[196:199], v4, s[12:15], s63 offen
s_add_u32 s63, s54, 16384
buffer_load_dwordx4 v[200:203], v4, s[12:15], s63 offen
s_add_u32 s63, s54, 24576
buffer_load_dwordx4 v[204:207], v4, s[12:15], s63 offen
s_add_u32 s63, s54, 131072
buffer_load_dwordx4 v[208:211], v4, s[12:15], s63 offen
s_add_u32 s63, s54, 139264
buffer_load_dwordx4 v[212:215], v4, s[12:15], s63 offen
s_add_u32 s63, s54, 147456
buffer_load_dwordx4 v[216:219], v4, s[12:15], s63 offen
s_add_u32 s63, s54, 155648
buffer_load_dwordx4 v[220:223], v4, s[12:15], s63 offen
v_perm_b32 v16, v228, v224, s60
v_perm_b32 v17, v236, v232, s60
v_perm_b32 v18, v244, v240, s60
v_perm_b32 v19, v252, v248, s60
v_accvgpr_write_b32 a196, v16
v_accvgpr_write_b32 a197, v17
v_accvgpr_write_b32 a198, v18
v_accvgpr_write_b32 a199, v19
v_perm_b32 v20, v228, v224, s61
v_perm_b32 v21, v236, v232, s61
v_perm_b32 v22, v244, v240, s61
v_perm_b32 v23, v252, v248, s61
v_accvgpr_write_b32 a204, v20
v_accvgpr_write_b32 a205, v21
v_accvgpr_write_b32 a206, v22
v_accvgpr_write_b32 a207, v23
v_perm_b32 v16, v229, v225, s60
v_perm_b32 v17, v237, v233, s60
v_perm_b32 v18, v245, v241, s60
v_perm_b32 v19, v253, v249, s60
v_accvgpr_write_b32 a212, v16
v_accvgpr_write_b32 a213, v17
v_accvgpr_write_b32 a214, v18
v_accvgpr_write_b32 a215, v19
v_perm_b32 v20, v229, v225, s61
v_perm_b32 v21, v237, v233, s61
v_perm_b32 v22, v245, v241, s61
v_perm_b32 v23, v253, v249, s61
v_accvgpr_write_b32 a220, v20
v_accvgpr_write_b32 a221, v21
v_accvgpr_write_b32 a222, v22
v_accvgpr_write_b32 a223, v23
v_perm_b32 v16, v230, v226, s60
v_perm_b32 v17, v238, v234, s60
v_perm_b32 v18, v246, v242, s60
v_perm_b32 v19, v254, v250, s60
v_accvgpr_write_b32 a228, v16
v_accvgpr_write_b32 a229, v17
v_accvgpr_write_b32 a230, v18
v_accvgpr_write_b32 a231, v19
v_perm_b32 v20, v230, v226, s61
v_perm_b32 v21, v238, v234, s61
v_perm_b32 v22, v246, v242, s61
v_perm_b32 v23, v254, v250, s61
v_accvgpr_write_b32 a236, v20
v_accvgpr_write_b32 a237, v21
v_accvgpr_write_b32 a238, v22
v_accvgpr_write_b32 a239, v23
v_perm_b32 v16, v231, v227, s60
v_perm_b32 v17, v239, v235, s60
v_perm_b32 v18, v247, v243, s60
v_perm_b32 v19, v255, v251, s60
v_accvgpr_write_b32 a244, v16
v_accvgpr_write_b32 a245, v17
v_accvgpr_write_b32 a246, v18
v_accvgpr_write_b32 a247, v19
v_perm_b32 v20, v231, v227, s61
v_perm_b32 v21, v239, v235, s61
v_perm_b32 v22, v247, v243, s61
v_perm_b32 v23, v255, v251, s61
v_accvgpr_write_b32 a252, v20
v_accvgpr_write_b32 a253, v21
v_accvgpr_write_b32 a254, v22
v_accvgpr_write_b32 a255, v23
s_waitcnt vmcnt(8)
s_add_u32 s63, s55, 0
buffer_load_dwordx4 v[224:227], v4, s[12:15], s63 offen
s_add_u32 s63, s55, 8192
buffer_load_dwordx4 v[228:231], v4, s[12:15], s63 offen
s_add_u32 s63, s55, 16384
buffer_load_dwordx4 v[232:235], v4, s[12:15], s63 offen
s_add_u32 s63, s55, 24576
buffer_load_dwordx4 v[236:239], v4, s[12:15], s63 offen
s_add_u32 s63, s55, 131072
buffer_load_dwordx4 v[240:243], v4, s[12:15], s63 offen
s_add_u32 s63, s55, 139264
buffer_load_dwordx4 v[244:247], v4, s[12:15], s63 offen
s_add_u32 s63, s55, 147456
buffer_load_dwordx4 v[248:251], v4, s[12:15], s63 offen
s_add_u32 s63, s55, 155648
buffer_load_dwordx4 v[252:255], v4, s[12:15], s63 offen
v_perm_b32 v16, v68, v64, s60
v_perm_b32 v17, v76, v72, s60
v_perm_b32 v18, v84, v80, s60
v_perm_b32 v19, v92, v88, s60
v_accvgpr_write_b32 a4, v16
v_accvgpr_write_b32 a5, v17
v_accvgpr_write_b32 a6, v18
v_accvgpr_write_b32 a7, v19
v_perm_b32 v20, v68, v64, s61
v_perm_b32 v21, v76, v72, s61
v_perm_b32 v22, v84, v80, s61
v_perm_b32 v23, v92, v88, s61
v_accvgpr_write_b32 a12, v20
v_accvgpr_write_b32 a13, v21
v_accvgpr_write_b32 a14, v22
v_accvgpr_write_b32 a15, v23
v_perm_b32 v16, v69, v65, s60
v_perm_b32 v17, v77, v73, s60
v_perm_b32 v18, v85, v81, s60
v_perm_b32 v19, v93, v89, s60
v_accvgpr_write_b32 a20, v16
v_accvgpr_write_b32 a21, v17
v_accvgpr_write_b32 a22, v18
v_accvgpr_write_b32 a23, v19
v_perm_b32 v20, v69, v65, s61
v_perm_b32 v21, v77, v73, s61
v_perm_b32 v22, v85, v81, s61
v_perm_b32 v23, v93, v89, s61
v_accvgpr_write_b32 a28, v20
v_accvgpr_write_b32 a29, v21
v_accvgpr_write_b32 a30, v22
v_accvgpr_write_b32 a31, v23
v_perm_b32 v16, v70, v66, s60
v_perm_b32 v17, v78, v74, s60
v_perm_b32 v18, v86, v82, s60
v_perm_b32 v19, v94, v90, s60
v_accvgpr_write_b32 a36, v16
v_accvgpr_write_b32 a37, v17
v_accvgpr_write_b32 a38, v18
v_accvgpr_write_b32 a39, v19
v_perm_b32 v20, v70, v66, s61
v_perm_b32 v21, v78, v74, s61
v_perm_b32 v22, v86, v82, s61
v_perm_b32 v23, v94, v90, s61
v_accvgpr_write_b32 a44, v20
v_accvgpr_write_b32 a45, v21
v_accvgpr_write_b32 a46, v22
v_accvgpr_write_b32 a47, v23
v_perm_b32 v16, v71, v67, s60
v_perm_b32 v17, v79, v75, s60
v_perm_b32 v18, v87, v83, s60
v_perm_b32 v19, v95, v91, s60
v_accvgpr_write_b32 a52, v16
v_accvgpr_write_b32 a53, v17
v_accvgpr_write_b32 a54, v18
v_accvgpr_write_b32 a55, v19
v_perm_b32 v20, v71, v67, s61
v_perm_b32 v21, v79, v75, s61
v_perm_b32 v22, v87, v83, s61
v_perm_b32 v23, v95, v91, s61
v_accvgpr_write_b32 a60, v20
v_accvgpr_write_b32 a61, v21
v_accvgpr_write_b32 a62, v22
v_accvgpr_write_b32 a63, v23
s_waitcnt vmcnt(8)
buffer_load_dwordx2 v[106:107], v14, s[4:7], s76 offen sc1
v_perm_b32 v16, v196, v192, s60
v_perm_b32 v17, v204, v200, s60
v_perm_b32 v18, v212, v208, s60
v_perm_b32 v19, v220, v216, s60
v_accvgpr_write_b32 a64, v16
v_accvgpr_write_b32 a65, v17
v_accvgpr_write_b32 a66, v18
v_accvgpr_write_b32 a67, v19
v_perm_b32 v20, v196, v192, s61
v_perm_b32 v21, v204, v200, s61
v_perm_b32 v22, v212, v208, s61
v_perm_b32 v23, v220, v216, s61
v_accvgpr_write_b32 a72, v20
v_accvgpr_write_b32 a73, v21
v_accvgpr_write_b32 a74, v22
v_accvgpr_write_b32 a75, v23
v_perm_b32 v16, v197, v193, s60
v_perm_b32 v17, v205, v201, s60
v_perm_b32 v18, v213, v209, s60
v_perm_b32 v19, v221, v217, s60
v_accvgpr_write_b32 a80, v16
v_accvgpr_write_b32 a81, v17
v_accvgpr_write_b32 a82, v18
v_accvgpr_write_b32 a83, v19
v_perm_b32 v20, v197, v193, s61
v_perm_b32 v21, v205, v201, s61
v_perm_b32 v22, v213, v209, s61
v_perm_b32 v23, v221, v217, s61
v_accvgpr_write_b32 a88, v20
v_accvgpr_write_b32 a89, v21
v_accvgpr_write_b32 a90, v22
v_accvgpr_write_b32 a91, v23
v_perm_b32 v16, v198, v194, s60
v_perm_b32 v17, v206, v202, s60
v_perm_b32 v18, v214, v210, s60
v_perm_b32 v19, v222, v218, s60
v_accvgpr_write_b32 a96, v16
v_accvgpr_write_b32 a97, v17
v_accvgpr_write_b32 a98, v18
v_accvgpr_write_b32 a99, v19
v_perm_b32 v20, v198, v194, s61
v_perm_b32 v21, v206, v202, s61
v_perm_b32 v22, v214, v210, s61
v_perm_b32 v23, v222, v218, s61
v_accvgpr_write_b32 a104, v20
v_accvgpr_write_b32 a105, v21
v_accvgpr_write_b32 a106, v22
v_accvgpr_write_b32 a107, v23
v_perm_b32 v16, v199, v195, s60
v_perm_b32 v17, v207, v203, s60
v_perm_b32 v18, v215, v211, s60
v_perm_b32 v19, v223, v219, s60
v_accvgpr_write_b32 a112, v16
v_accvgpr_write_b32 a113, v17
v_accvgpr_write_b32 a114, v18
v_accvgpr_write_b32 a115, v19
v_perm_b32 v20, v199, v195, s61
v_perm_b32 v21, v207, v203, s61
v_perm_b32 v22, v215, v211, s61
v_perm_b32 v23, v223, v219, s61
v_accvgpr_write_b32 a120, v20
v_accvgpr_write_b32 a121, v21
v_accvgpr_write_b32 a122, v22
v_accvgpr_write_b32 a123, v23
s_waitcnt vmcnt(0)
v_max_u32 v108, v106, v107
v_cmp_eq_u32 vcc, -1, v108
s_cbranch_vccnz L_T_nd
s_mov_b32 m0, s68
s_mov_b32 s63, s69
buffer_load_dwordx4 v8, s[4:7], s63 offen sc1 lds
s_addk_i32 m0, 0x400
s_addk_i32 s63, 0x1000
buffer_load_dwordx4 v8, s[4:7], s63 offen sc1 lds
s_addk_i32 m0, 0x400
s_addk_i32 s63, 0x1000
buffer_load_dwordx4 v9, s[4:7], s63 offen sc1 lds
s_addk_i32 m0, 0x400
s_addk_i32 s63, 0x1000
buffer_load_dwordx4 v9, s[4:7], s63 offen sc1 lds
s_addk_i32 m0, 0x400
s_addk_i32 s63, 0x1000
buffer_load_dwordx4 v8, s[4:7], s63 offen sc1 lds
s_addk_i32 m0, 0x400
s_addk_i32 s63, 0x1000
buffer_load_dwordx4 v8, s[4:7], s63 offen sc1 lds
s_addk_i32 m0, 0x400
s_addk_i32 s63, 0x1000
buffer_load_dwordx4 v9, s[4:7], s63 offen sc1 lds
s_addk_i32 m0, 0x400
s_addk_i32 s63, 0x1000
buffer_load_dwordx4 v9, s[4:7], s63 offen sc1 lds
L_T_nd:
v_perm_b32 v16, v228, v224, s60
v_perm_b32 v17, v236, v232, s60
v_perm_b32 v18, v244, v240, s60
v_perm_b32 v19, v252, v248, s60
v_accvgpr_write_b32 a68, v16
v_accvgpr_write_b32 a69, v17
v_accvgpr_write_b32 a70, v18
v_accvgpr_write_b32 a71, v19
v_perm_b32 v20, v228, v224, s61
v_perm_b32 v21, v236, v232, s61
v_perm_b32 v22, v244, v240, s61
v_perm_b32 v23, v252, v248, s61
v_accvgpr_write_b32 a76, v20
v_accvgpr_write_b32 a77, v21
v_accvgpr_write_b32 a78, v22
v_accvgpr_write_b32 a79, v23
v_perm_b32 v16, v229, v225, s60
v_perm_b32 v17, v237, v233, s60
v_perm_b32 v18, v245, v241, s60
v_perm_b32 v19, v253, v249, s60
v_accvgpr_write_b32 a84, v16
v_accvgpr_write_b32 a85, v17
v_accvgpr_write_b32 a86, v18
v_accvgpr_write_b32 a87, v19
v_perm_b32 v20, v229, v225, s61
v_perm_b32 v21, v237, v233, s61
v_perm_b32 v22, v245, v241, s61
v_perm_b32 v23, v253, v249, s61
v_accvgpr_write_b32 a92, v20
v_accvgpr_write_b32 a93, v21
v_accvgpr_write_b32 a94, v22
v_accvgpr_write_b32 a95, v23
v_perm_b32 v16, v230, v226, s60
v_perm_b32 v17, v238, v234, s60
v_perm_b32 v18, v246, v242, s60
v_perm_b32 v19, v254, v250, s60
v_accvgpr_write_b32 a100, v16
v_accvgpr_write_b32 a101, v17
v_accvgpr_write_b32 a102, v18
v_accvgpr_write_b32 a103, v19
v_perm_b32 v20, v230, v226, s61
v_perm_b32 v21, v238, v234, s61
v_perm_b32 v22, v246, v242, s61
v_perm_b32 v23, v254, v250, s61
v_accvgpr_write_b32 a108, v20
v_accvgpr_write_b32 a109, v21
v_accvgpr_write_b32 a110, v22
v_accvgpr_write_b32 a111, v23
v_perm_b32 v16, v231, v227, s60
v_perm_b32 v17, v239, v235, s60
v_perm_b32 v18, v247, v243, s60
v_perm_b32 v19, v255, v251, s60
v_accvgpr_write_b32 a116, v16
v_accvgpr_write_b32 a117, v17
v_accvgpr_write_b32 a118, v18
v_accvgpr_write_b32 a119, v19
v_perm_b32 v20, v231, v227, s61
v_perm_b32 v21, v239, v235, s61
v_perm_b32 v22, v247, v243, s61
v_perm_b32 v23, v255, v251, s61
v_accvgpr_write_b32 a124, v20
v_accvgpr_write_b32 a125, v21
v_accvgpr_write_b32 a126, v22
v_accvgpr_write_b32 a127, v23
s_cbranch_vccz L_T_go
s_mov_b32 s64, 400000
s_branch plf_12
pl_10:
s_sleep 1
plf_12:
buffer_load_dwordx2 v[106:107], v14, s[4:7], s76 offen sc1
s_sub_u32 s64, s64, 1
s_cmp_eq_u32 s64, 0
s_waitcnt vmcnt(0)
s_cbranch_scc1 ple_11
v_max_u32 v108, v106, v107
v_cmp_eq_u32 vcc, -1, v108
s_cbranch_vccnz pl_10
ple_11:
s_mov_b32 m0, s68
s_mov_b32 s63, s69
buffer_load_dwordx4 v8, s[4:7], s63 offen sc1 lds
s_addk_i32 m0, 0x400
s_addk_i32 s63, 0x1000
buffer_load_dwordx4 v8, s[4:7], s63 offen sc1 lds
s_addk_i32 m0, 0x400
s_addk_i32 s63, 0x1000
buffer_load_dwordx4 v9, s[4:7], s63 offen sc1 lds
s_addk_i32 m0, 0x400
s_addk_i32 s63, 0x1000
buffer_load_dwordx4 v9, s[4:7], s63 offen sc1 lds
s_addk_i32 m0, 0x400
s_addk_i32 s63, 0x1000
buffer_load_dwordx4 v8, s[4:7], s63 offen sc1 lds
s_addk_i32 m0, 0x400
s_addk_i32 s63, 0x1000
buffer_load_dwordx4 v8, s[4:7], s63 offen sc1 lds
s_addk_i32 m0, 0x400
s_addk_i32 s63, 0x1000
buffer_load_dwordx4 v9, s[4:7], s63 offen sc1 lds
s_addk_i32 m0, 0x400
s_addk_i32 s63, 0x1000
buffer_load_dwordx4 v9, s[4:7], s63 offen sc1 lds
L_T_go:
v_mov_b32 v34, v106
s_nop 1
v_max_f32_dpp v34, v34, v34 quad_perm:[1,0,3,2] row_mask:0xf bank_mask:0xf
s_nop 1
v_max_f32_dpp v34, v34, v34 quad_perm:[2,3,0,1] row_mask:0xf bank_mask:0xf
s_nop 1
v_max_f32_dpp v34, v34, v34 row_half_mirror row_mask:0xf bank_mask:0xf
s_nop 1
v_max_f32_dpp v34, v34, v34 row_mirror row_mask:0xf bank_mask:0xf
v_mov_b32 v35, v34
s_nop 1
v_permlane16_swap_b32 v34, v35
v_max_f32 v34, v34, v35
v_sub_f32 v34, v106, v34
v_cvt_i32_f32 v34, v34
v_ldexp_f32 v34, 1.0, v34
ds_write_b16_d16_hi v13, v34 offset:49152
v_mul_f32 v31, v34, v107
ds_read_b128 v[24:27], v15 offset:49152
s_nop 1
v_add_f32_dpp v31, v31, v31 quad_perm:[1,0,3,2] row_mask:0xf bank_mask:0xf
s_nop 1
v_add_f32_dpp v31, v31, v31 quad_perm:[2,3,0,1] row_mask:0xf bank_mask:0xf
s_nop 1
v_add_f32_dpp v31, v31, v31 row_half_mirror row_mask:0xf bank_mask:0xf
s_nop 1
v_add_f32_dpp v31, v31, v31 row_mirror row_mask:0xf bank_mask:0xf
v_mov_b32 v35, v31
s_nop 1
v_permlane16_swap_b32 v31, v35
v_add_f32 v31, v31, v35
v_rcp_f32 v31, v31
s_mov_b32 s64, 100000
L_T_pay:
s_waitcnt vmcnt(0) lgkmcnt(0)
ds_read_b64_tr_b16 v[32:33], v112
ds_read_b64_tr_b16 v[34:35], v112 offset:1024
ds_read_b64_tr_b16 v[36:37], v113
ds_read_b64_tr_b16 v[38:39], v113 offset:1024
ds_read_b64_tr_b16 v[40:41], v114
ds_read_b64_tr_b16 v[42:43], v114 offset:1024
ds_read_b64_tr_b16 v[44:45], v115
ds_read_b64_tr_b16 v[46:47], v115 offset:1024
ds_read_b64_tr_b16 v[48:49], v116
ds_read_b64_tr_b16 v[50:51], v116 offset:1024
ds_read_b64_tr_b16 v[52:53], v117
ds_read_b64_tr_b16 v[54:55], v117 offset:1024
s_waitcnt lgkmcnt(8)
ds_read_b64_tr_b16 v[56:57], v118
ds_read_b64_tr_b16 v[58:59], v118 offset:1024
ds_read_b64_tr_b16 v[60:61], v119
ds_read_b64_tr_b16 v[62:63], v119 offset:1024
s_waitcnt lgkmcnt(14)
v_mfma_f32_16x16x32_bf16 v[64:67], v[32:35], v[24:27], 0
s_waitcnt lgkmcnt(12)
v_mfma_f32_16x16x32_bf16 v[68:71], v[36:39], v[24:27], 0
s_waitcnt lgkmcnt(10)
v_mfma_f32_16x16x32_bf16 v[72:75], v[40:43], v[24:27], 0
s_waitcnt lgkmcnt(8)
v_mfma_f32_16x16x32_bf16 v[76:79], v[44:47], v[24:27], 0
s_waitcnt lgkmcnt(6)
v_mfma_f32_16x16x32_bf16 v[80:83], v[48:51], v[24:27], 0
s_waitcnt lgkmcnt(4)
v_mfma_f32_16x16x32_bf16 v[84:87], v[52:55], v[24:27], 0
s_waitcnt lgkmcnt(2)
v_mfma_f32_16x16x32_bf16 v[88:91], v[56:59], v[24:27], 0
s_waitcnt lgkmcnt(0)
v_mfma_f32_16x16x32_bf16 v[92:95], v[60:63], v[24:27], 0
v_cvt_pk_bf16_f32 v96, v64, v65
v_cvt_pk_bf16_f32 v104, v66, v67
v_cndmask_b32 v96, v96, v104, s[70:71]
v_cvt_pk_bf16_f32 v97, v68, v69
v_cvt_pk_bf16_f32 v105, v70, v71
v_cndmask_b32 v97, v97, v105, s[70:71]
v_cvt_pk_bf16_f32 v98, v72, v73
v_cvt_pk_bf16_f32 v104, v74, v75
v_cndmask_b32 v98, v98, v104, s[70:71]
v_cvt_pk_bf16_f32 v99, v76, v77
v_cvt_pk_bf16_f32 v105, v78, v79
v_cndmask_b32 v99, v99, v105, s[70:71]
v_cvt_pk_bf16_f32 v100, v80, v81
v_cvt_pk_bf16_f32 v104, v82, v83
v_cndmask_b32 v100, v100, v104, s[70:71]
v_smfmac_f32_16x16x64_bf16 v[128:131], v[96:99], a[0:7], v29
v_cvt_pk_bf16_f32 v101, v84, v85
v_cvt_pk_bf16_f32 v105, v86, v87
v_cndmask_b32 v101, v101, v105, s[70:71]
v_smfmac_f32_16x16x64_bf16 v[132:135], v[96:99], a[8:15], v29
v_smfmac_f32_16x16x64_bf16 v[136:139], v[96:99], a[16:23], v29
v_cvt_pk_bf16_f32 v102, v88, v89
v_cvt_pk_bf16_f32 v104, v90, v91
v_cndmask_b32 v102, v102, v104, s[70:71]
v_smfmac_f32_16x16x64_bf16 v[140:143], v[96:99], a[24:31], v29
v_smfmac_f32_16x16x64_bf16 v[144:147], v[96:99], a[32:39], v29
v_cvt_pk_bf16_f32 v103, v92, v93
v_cvt_pk_bf16_f32 v105, v94, v95
v_cndmask_b32 v103, v103, v105, s[70:71]
v_smfmac_f32_16x16x64_bf16 v[148:151], v[96:99], a[40:47], v29
v_smfmac_f32_16x16x64_bf16 v[152:155], v[96:99], a[48:55], v29
v_smfmac_f32_16x16x64_bf16 v[156:159], v[96:99], a[56:63], v29
v_smfmac_f32_16x16x64_bf16 v[128:131], v[100:103], a[64:71], v29
v_smfmac_f32_16x16x64_bf16 v[132:135], v[100:103], a[72:79], v29
v_smfmac_f32_16x16x64_bf16 v[136:139], v[100:103], a[80:87], v29
v_smfmac_f32_16x16x64_bf16 v[140:143], v[100:103], a[88:95], v29
v_smfmac_f32_16x16x64_bf16 v[144:147], v[100:103], a[96:103], v29
v_smfmac_f32_16x16x64_bf16 v[148:151], v[100:103], a[104:111], v29
v_smfmac_f32_16x16x64_bf16 v[152:155], v[100:103], a[112:119], v29
v_smfmac_f32_16x16x64_bf16 v[156:159], v[100:103], a[120:127], v29
s_nop 0
v_add_f32 v128, v128, v129
v_add_f32 v132, v132, v133
v_add_f32 v136, v136, v137
v_add_f32 v140, v140, v141
v_add_f32 v144, v144, v145
v_add_f32 v148, v148, v149
v_add_f32 v152, v152, v153
v_add_f32 v156, v156, v157
v_cvt_pk_bf16_f32 v64, v128, v132
v_cvt_pk_bf16_f32 v65, v136, v140
v_cvt_pk_bf16_f32 v66, v144, v148
v_cvt_pk_bf16_f32 v67, v152, v156
s_mov_b64 exec, 0xffff
ds_write_b128 v121, v[64:67] offset:49664
s_mov_b64 exec, -1
s_waitcnt lgkmcnt(0)
s_barrier
ds_read_b128 v[96:99], v122 offset:49664
ds_read_b128 v[100:103], v123 offset:49664
s_waitcnt lgkmcnt(1)
v_smfmac_f32_16x16x64_bf16 v[160:163], v[96:99], a[128:135], v30
v_smfmac_f32_16x16x64_bf16 v[176:179], v[96:99], a[160:167], v30
v_smfmac_f32_16x16x64_bf16 v[164:167], v[96:99], a[136:143], v30
v_smfmac_f32_16x16x64_bf16 v[180:183], v[96:99], a[168:175], v30
v_smfmac_f32_16x16x64_bf16 v[168:171], v[96:99], a[144:151], v30
v_smfmac_f32_16x16x64_bf16 v[184:187], v[96:99], a[176:183], v30
v_smfmac_f32_16x16x64_bf16 v[172:175], v[96:99], a[152:159], v30
v_smfmac_f32_16x16x64_bf16 v[188:191], v[96:99], a[184:191], v30
s_waitcnt lgkmcnt(0)
v_smfmac_f32_16x16x64_bf16 v[160:163], v[100:103], a[192:199], v30
v_smfmac_f32_16x16x64_bf16 v[176:179], v[100:103], a[224:231], v30
v_smfmac_f32_16x16x64_bf16 v[164:167], v[100:103], a[200:207], v30
v_smfmac_f32_16x16x64_bf16 v[180:183], v[100:103], a[232:239], v30
v_smfmac_f32_16x16x64_bf16 v[168:171], v[100:103], a[208:215], v30
v_smfmac_f32_16x16x64_bf16 v[184:187], v[100:103], a[240:247], v30
v_smfmac_f32_16x16x64_bf16 v[172:175], v[100:103], a[216:223], v30
v_smfmac_f32_16x16x64_bf16 v[188:191], v[100:103], a[248:255], v30
s_nop 0
v_add_f32 v160, v160, v161
v_add_f32 v162, v162, v163
v_add_f32 v176, v176, v177
v_add_f32 v178, v178, v179
v_add_f32 v164, v164, v165
v_add_f32 v166, v166, v167
v_add_f32 v180, v180, v181
v_add_f32 v182, v182, v183
v_add_f32 v168, v168, v169
v_add_f32 v170, v170, v171
v_add_f32 v184, v184, v185
v_add_f32 v186, v186, v187
v_add_f32 v172, v172, v173
v_add_f32 v174, v174, v175
v_add_f32 v188, v188, v189
v_add_f32 v190, v190, v191
v_add_f32 v160, v160, v162
v_add_f32 v176, v176, v178
v_add_f32 v164, v164, v166
v_add_f32 v180, v180, v182
v_add_f32 v168, v168, v170
v_add_f32 v184, v184, v186
v_add_f32 v172, v172, v174
v_add_f32 v188, v188, v190
v_permlane16_swap_b32 v160, v176
v_permlane16_swap_b32 v164, v180
v_permlane16_swap_b32 v168, v184
v_permlane16_swap_b32 v172, v188
v_add_f32 v160, v160, v176
v_add_f32 v164, v164, v180
v_add_f32 v168, v168, v184
v_add_f32 v172, v172, v188
v_mul_f32 v160, v31, v160
v_mul_f32 v164, v31, v164
v_mul_f32 v168, v31, v168
v_mul_f32 v172, v31, v172
v_cvt_pk_bf16_f32 v64, v160, v164
v_cvt_pk_bf16_f32 v65, v168, v172
s_mov_b32 exec_hi, 0
buffer_store_dwordx2 v[64:65], v120, s[4:7], s78 offen sc1
s_mov_b64 exec, -1
s_cmp_lt_u32 s43, 16
s_cbranch_scc1 L_fin
s_cmp_lg_u32 s3, 0
s_cbranch_scc1 L_fin
s_mov_b32 s12, s36
s_and_b32 s13, s37, 0xffff
s_mov_b32 s14, 4096
s_mov_b32 s15, 0x20000
v_lshrrev_b32 v4, 3, v1
v_and_b32 v5, 7, v1
v_lshlrev_b32 v6, 11, v4
v_lshl_add_u32 v6, v5, 4, v6
v_mov_b32 v7, 1073741824
v_cmp_gt_u32 vcc, 5, v4
s_nop 1
v_cndmask_b32 v7, v7, v6, vcc
v_and_b32 v9, 1, v3
v_lshrrev_b32 v10, 1, v3
v_lshl_add_u32 v9, v9, 1, v10
v_lshl_add_u32 v9, v5, 2, v9
v_lshlrev_b32 v8, 2, v9
v_lshlrev_b32 v10, 1, v9
s_mov_b32 s70, 0x00ff00ff
s_mov_b32 s71, 0x00ff00ff
s_lshl_b32 s62, s73, 16
s_sub_u32 s65, s43, 16
s_lshl_b32 s63, s65, 7
s_add_u32 s62, s62, s63
s_add_u32 s62, s62, 6291456
s_lshl_b32 s74, s73, 10
s_lshl_b32 s63, s65, 6
s_add_u32 s74, s74, s63
s_add_u32 s76, s62, 16384
s_add_u32 s77, s62, 32768
s_add_u32 s78, s62, 49152
s_add_u32 s79, s62, 63488
s_mov_b32 s64, 400000
pl_13:
buffer_load_dwordx4 v[32:35], v6, s[4:7], s62 offen sc1
buffer_load_dwordx4 v[36:39], v6, s[4:7], s76 offen sc1
buffer_load_dwordx4 v[40:43], v6, s[4:7], s77 offen sc1
buffer_load_dwordx4 v[44:47], v7, s[4:7], s78 offen sc1
buffer_load_dword v56, v8, s[4:7], s79 offen sc1
s_sub_u32 s64, s64, 1
s_cmp_eq_u32 s64, 0
s_waitcnt vmcnt(0)
s_cbranch_scc1 ple_14
v_add_f32 v32, v32, v36
v_add_f32 v40, v40, v44
v_add_f32 v33, v33, v37
v_add_f32 v41, v41, v45
v_add_f32 v34, v34, v38
v_add_f32 v42, v42, v46
v_add_f32 v35, v35, v39
v_add_f32 v43, v43, v47
v_add_f32 v32, v32, v40
v_add_f32 v33, v33, v41
v_add_f32 v34, v34, v42
v_add_f32 v35, v35, v43
v_cvt_pk_bf16_f32 v44, v56, v56
v_add_f32_dpp v32, v32, v32 row_ror:8 row_mask:0xf bank_mask:0xf
v_add_f32_dpp v33, v33, v33 row_ror:8 row_mask:0xf bank_mask:0xf
v_add_f32_dpp v34, v34, v34 row_ror:8 row_mask:0xf bank_mask:0xf
v_add_f32_dpp v35, v35, v35 row_ror:8 row_mask:0xf bank_mask:0xf
v_lshlrev_b32 v44, 16, v44
v_permlane16_swap_b32 v32, v34
v_permlane16_swap_b32 v33, v35
v_add_f32 v32, v32, v34
v_add_f32 v33, v33, v35
s_nop 1
v_permlane32_swap_b32 v32, v33
v_add_f32 v32, v32, v33
v_cmp_u_f32 vcc, v32, v56
v_cvt_pk_bf16_f32 v32, v32, v32
s_cbranch_vccnz pl_13
ple_14:
v_lshlrev_b32 v32, 16, v32
v_add_f32 v32, v32, v44
v_cvt_pk_bf16_f32 v32, v32, v32
s_mov_b64 exec, s[70:71]
buffer_store_short v32, v10, s[12:15], s74 offen
s_mov_b64 exec, -1
s_branch L_fin
L_A:
v_lshlrev_b32 v4, 4, v1
s_lshr_b32 s74, s42, 5
s_and_b32 s75, s42, 31
s_lshl_b32 s76, s74, 23
s_lshl_b32 s77, s75, 15
s_add_u32 s76, s76, s77
s_lshl_b32 s77, s3, 13
s_add_u32 s76, s76, s77
s_and_b32 s62, s3, 1
s_lshl_b32 s62, s62, 5
v_xor_b32 v7, s62, v4
v_xor_b32 v160, 0, v7
v_xor_b32 v161, 64, v7
v_xor_b32 v162, 128, v7
v_xor_b32 v163, 192, v7
v_xor_b32 v164, 4112, v7
v_xor_b32 v165, 4176, v7
v_xor_b32 v166, 4240, v7
v_xor_b32 v167, 4304, v7
s_add_u32 s62, s77, 131072
v_add_u32 v15, s62, v7
v_mov_b32 v48, -1
v_mov_b32 v49, -1
v_mov_b32 v50, -1
v_mov_b32 v51, -1
s_waitcnt lgkmcnt(0)
s_mov_b32 s4, s40
s_and_b32 s5, s41, 0xffff
s_mov_b32 s6, 268435456
s_mov_b32 s7, 0x20000
s_cmp_ge_u32 s42, 16
s_cbranch_scc1 L_A_ni
s_lshl_b32 s62, s42, 13
s_lshl_b32 s63, s3, 11
s_add_u32 s62, s62, s63
buffer_store_dwordx4 v[48:51], v4, s[4:7], s62 offen offset:0 sc1
buffer_store_dwordx4 v[48:51], v4, s[4:7], s62 offen offset:1024 sc1
L_A_ni:
s_cmp_lg_u32 s74, 1
s_cbranch_scc1 L_A_nu
s_mov_b32 s44, s22
s_and_b32 s45, s23, 0xffff
s_mov_b32 s46, 4194304
s_mov_b32 s47, 0x20000
v_lshrrev_b32 v8, 1, v1
v_lshlrev_b32 v8, 13, v8
v_and_b32 v9, 1, v1
v_lshl_add_u32 v8, v9, 7, v8
s_lshl_b32 s62, s73, 20
s_lshl_b32 s63, s3, 18
s_add_u32 s62, s62, s63
s_lshl_b32 s63, s72, 8
s_add_u32 s62, s62, s63
buffer_load_dword v47, v8, s[44:47], s62 offen
L_A_nu:
s_mov_b32 s12, s18
s_and_b32 s13, s19, 0xffff
s_mov_b32 s14, 33554432
s_mov_b32 s15, 0x20000
s_mov_b32 s8, s38
s_and_b32 s9, s39, 0xffff
s_mov_b32 s10, 256
s_mov_b32 s11, 0x20000
v_and_b32 v5, 31, v1
v_lshrrev_b32 v6, 5, v1
v_and_b32 v8, 3, v5
v_lshlrev_b32 v8, 2, v8
v_bfe_u32 v9, v5, 2, 2
v_or_b32 v8, v8, v9
v_xor_b32 v8, v8, v6
v_lshlrev_b32 v10, 10, v5
v_lshl_add_u32 v10, v8, 4, v10
v_add_u32 v11, 131072, v10
s_lshl_b32 s62, s3, 15
v_add_u32 v10, s62, v10
v_xor_b32 v16, 0, v10
v_xor_b32 v17, 32, v10
v_xor_b32 v18, 64, v10
v_xor_b32 v19, 96, v10
v_xor_b32 v20, 128, v10
v_xor_b32 v21, 160, v10
v_xor_b32 v22, 192, v10
v_xor_b32 v23, 224, v10
v_xor_b32 v128, 0, v11
v_xor_b32 v129, 32, v11
v_xor_b32 v130, 64, v11
v_xor_b32 v131, 96, v11
v_xor_b32 v132, 128, v11
v_xor_b32 v133, 160, v11
v_xor_b32 v134, 192, v11
v_xor_b32 v135, 224, v11
v_bfe_u32 v8, v1, 2, 2
v_lshl_add_u32 v9, v6, 2, v8
v_lshlrev_b32 v12, 10, v9
v_and_b32 v9, 1, v1
v_lshlrev_b32 v9, 1, v9
v_bfe_u32 v13, v1, 4, 1
v_or_b32 v9, v9, v13
v_lshl_add_u32 v13, v8, 2, v6
v_xor_b32 v9, v9, v13
v_lshl_add_u32 v12, v9, 4, v12
v_bfe_u32 v9, v1, 1, 1
v_lshl_add_u32 v12, v9, 3, v12
s_lshl_b32 s62, s3, 8
v_add_u32 v12, s62, v12
v_xor_b32 v24, 0, v12
v_add_u32 v32, 0x10000, v24
v_xor_b32 v25, 32, v12
v_add_u32 v33, 0x10000, v25
v_xor_b32 v26, 64, v12
v_add_u32 v34, 0x10000, v26
v_xor_b32 v27, 96, v12
v_add_u32 v35, 0x10000, v27
v_xor_b32 v28, 128, v12
v_add_u32 v36, 0x10000, v28
v_xor_b32 v29, 160, v12
v_add_u32 v37, 0x10000, v29
v_xor_b32 v30, 192, v12
v_add_u32 v38, 0x10000, v30
v_xor_b32 v31, 224, v12
v_add_u32 v39, 0x10000, v31
v_lshlrev_b32 v40, 5, v5
v_lshl_add_u32 v40, v6, 4, v40
v_add_u32 v40, 131072, v40
v_xor_b32 v46, 16, v40
s_lshl_b32 s62, s3, 2
v_add_u32 v41, s62, v40
v_add_u32 v42, 133120, v4
s_lshl_b32 s62, s3, 11
v_add_u32 v43, s62, v42
s_lshl_b32 s78, s74, 15
s_add_u32 s78, s78, s77
s_add_u32 s67, s78, 0x1000
v_mov_b32 v12, 0
v_mov_b32 v13, 1
v_xor_b32 v168, 0, v15
v_xor_b32 v169, 64, v15
v_xor_b32 v170, 128, v15
v_xor_b32 v171, 192, v15
v_xor_b32 v172, 16, v15
v_xor_b32 v173, 80, v15
v_xor_b32 v174, 144, v15
v_xor_b32 v175, 208, v15
s_add_u32 m0, s77, 0
s_nop 0
buffer_load_dwordx4 v160, s[12:15], s76 offen offset:0 nt lds
v_and_b32 v8, 7, v5
v_lshlrev_b32 v9, 1, v6
v_xor_b32 v8, v8, v9
v_lshlrev_b32 v208, 10, v5
v_lshl_add_u32 v208, v8, 4, v208
s_lshl_b32 s62, s3, 8
v_add_u32 v208, s62, v208
v_xor_b32 v209, 16, v208
v_xor_b32 v210, 64, v208
v_xor_b32 v211, 80, v208
v_lshrrev_b32 v8, 3, v1
v_and_b32 v9, 7, v1
v_lshlrev_b32 v212, 10, v8
v_lshl_add_u32 v212, v9, 4, v212
v_add_u32 v212, s62, v212
v_lshlrev_b32 v214, 12, v8
v_lshl_add_u32 v214, v9, 4, v214
v_xor_b32 v9, v9, v8
v_lshlrev_b32 v213, 15, v8
v_lshl_add_u32 v213, v9, 4, v213
s_lshl_b32 s63, s3, 5
v_lshl_add_u32 v215, v8, 2, s63
s_lshl_b32 s65, s74, 20
s_lshl_b32 s63, s75, 10
s_add_u32 s65, s65, s63
s_add_u32 s65, s65, s62
s_add_u32 s65, s65, 1048576
s_lshl_b32 s79, s74, 17
s_lshl_b32 s63, s75, 7
s_add_u32 s79, s79, s63
s_add_u32 s79, s79, 262144
s_lshl_b32 s63, s3, 15
s_add_u32 s79, s79, s63
s_mov_b32 s44, s30
s_and_b32 s45, s31, 0xffff
s_mov_b32 s46, 1409024
s_mov_b32 s47, 0x20000
s_mov_b32 s48, s32
s_and_b32 s49, s33, 0xffff
s_mov_b32 s50, 1409024
s_mov_b32 s51, 0x20000
s_mov_b32 s52, s34
s_and_b32 s53, s35, 0xffff
s_mov_b32 s54, 1409024
s_mov_b32 s55, 0x20000
v_lshrrev_b32 v218, 2, v1
v_mul_u32_u24 v218, 2752, v218
v_and_b32 v9, 3, v1
v_lshlrev_b32 v9, 7, v9
v_min_u32 v9, 380, v9
v_add_u32 v218, v218, v9
v_lshlrev_b32 v219, 7, v1
v_mov_b32 v9, 1073741824
v_cmp_gt_u32 vcc, 32, v1
s_lshr_b32 s62, s42, 3
s_lshl_b32 s62, s62, 2
v_cndmask_b32 v218, v9, v218, vcc
v_cmp_gt_u32 vcc, 24, v1
s_add_u32 s62, s62, s3
s_and_b32 s64, s42, 7
v_cndmask_b32 v219, v9, v219, vcc
s_mul_i32 s70, s62, 22016
s_mul_i32 s63, s64, 384
s_add_u32 s70, s70, s63
s_mul_i32 s71, s62, 3072
s_mul_i32 s63, s64, 196608
s_add_u32 s71, s71, s63
s_cmp_ge_u32 s42, 16
s_cbranch_scc1 L_A_ni2
s_waitcnt vmcnt(1)
s_barrier
s_cmp_lg_u32 s3, 0
s_cbranch_scc1 L_A_ni2
s_mov_b64 exec, 1
buffer_atomic_add v13, v12, s[8:11], 0 offen sc1
s_mov_b64 exec, -1
s_branch L_A_ni3
L_A_ni2:
s_cmp_eq_u32 s74, 1
s_cbranch_scc1 L_A_ni3
s_waitcnt vmcnt(0)
L_A_ni3:
buffer_load_dwordx4 v161, s[12:15], s76 offen offset:1024 nt lds
buffer_load_dwordx4 v162, s[12:15], s76 offen offset:2048 nt lds
buffer_load_dwordx4 v163, s[12:15], s76 offen offset:3072 nt lds
s_addk_i32 m0, 0x1000
s_nop 0
buffer_load_dwordx4 v164, s[12:15], s76 offen offset:0 nt lds
buffer_load_dwordx4 v165, s[12:15], s76 offen offset:1024 nt lds
buffer_load_dwordx4 v166, s[12:15], s76 offen offset:2048 nt lds
buffer_load_dwordx4 v167, s[12:15], s76 offen offset:3072 nt lds
s_add_u32 s69, s76, 360448
s_and_b32 s69, s69, 0xfffff
s_andn2_b32 s76, s76, 0xfffff
s_or_b32 s76, s76, s69
s_add_u32 s76, s76, 1048576
s_add_u32 m0, s77, 32768
s_nop 0
buffer_load_dwordx4 v160, s[12:15], s76 offen offset:0 nt lds
buffer_load_dwordx4 v161, s[12:15], s76 offen offset:1024 nt lds
buffer_load_dwordx4 v162, s[12:15], s76 offen offset:2048 nt lds
buffer_load_dwordx4 v163, s[12:15], s76 offen offset:3072 nt lds
s_addk_i32 m0, 0x1000
s_nop 0
buffer_load_dwordx4 v164, s[12:15], s76 offen offset:0 nt lds
buffer_load_dwordx4 v165, s[12:15], s76 offen offset:1024 nt lds
buffer_load_dwordx4 v166, s[12:15], s76 offen offset:2048 nt lds
buffer_load_dwordx4 v167, s[12:15], s76 offen offset:3072 nt lds
s_add_u32 s69, s76, 360448
s_and_b32 s69, s69, 0xfffff
s_andn2_b32 s76, s76, 0xfffff
s_or_b32 s76, s76, s69
s_add_u32 s76, s76, 1048576
s_add_u32 m0, s77, 65536
s_nop 0
buffer_load_dwordx4 v160, s[12:15], s76 offen offset:0 nt lds
buffer_load_dwordx4 v161, s[12:15], s76 offen offset:1024 nt lds
buffer_load_dwordx4 v162, s[12:15], s76 offen offset:2048 nt lds
buffer_load_dwordx4 v163, s[12:15], s76 offen offset:3072 nt lds
s_addk_i32 m0, 0x1000
s_nop 0
buffer_load_dwordx4 v164, s[12:15], s76 offen offset:0 nt lds
buffer_load_dwordx4 v165, s[12:15], s76 offen offset:1024 nt lds
buffer_load_dwordx4 v166, s[12:15], s76 offen offset:2048 nt lds
buffer_load_dwordx4 v167, s[12:15], s76 offen offset:3072 nt lds
s_add_u32 s69, s76, 360448
s_and_b32 s69, s69, 0xfffff
s_andn2_b32 s76, s76, 0xfffff
s_or_b32 s76, s76, s69
s_add_u32 s76, s76, 1048576
s_waitcnt vmcnt(16)
s_add_u32 m0, s77, 98304
s_nop 0
buffer_load_dwordx4 v160, s[12:15], s76 offen offset:0 nt lds
buffer_load_dwordx4 v161, s[12:15], s76 offen offset:1024 nt lds
buffer_load_dwordx4 v162, s[12:15], s76 offen offset:2048 nt lds
buffer_load_dwordx4 v163, s[12:15], s76 offen offset:3072 nt lds
s_addk_i32 m0, 0x1000
s_nop 0
buffer_load_dwordx4 v164, s[12:15], s76 offen offset:0 nt lds
buffer_load_dwordx4 v165, s[12:15], s76 offen offset:1024 nt lds
buffer_load_dwordx4 v166, s[12:15], s76 offen offset:2048 nt lds
buffer_load_dwordx4 v167, s[12:15], s76 offen offset:3072 nt lds
s_add_u32 s69, s76, 360448
s_and_b32 s69, s69, 0xfffff
s_andn2_b32 s76, s76, 0xfffff
s_or_b32 s76, s76, s69
s_add_u32 s76, s76, 1048576
buffer_load_dword v47, v12, s[8:11], 0 offen sc1
s_barrier
ds_read_b64_tr_b16 a[0:1], v24 offset:0
ds_read_b64_tr_b16 a[2:3], v25 offset:8192
ds_read_b64_tr_b16 a[4:5], v26 offset:0
ds_read_b64_tr_b16 a[6:7], v27 offset:8192
ds_read_b64_tr_b16 a[8:9], v28 offset:0
ds_read_b64_tr_b16 a[10:11], v29 offset:8192
ds_read_b64_tr_b16 a[12:13], v30 offset:0
ds_read_b64_tr_b16 a[14:15], v31 offset:8192
ds_read_b64_tr_b16 a[16:17], v24 offset:16384
ds_read_b64_tr_b16 a[18:19], v25 offset:24576
ds_read_b64_tr_b16 a[20:21], v26 offset:16384
ds_read_b64_tr_b16 a[22:23], v27 offset:24576
ds_read_b64_tr_b16 a[24:25], v28 offset:16384
ds_read_b64_tr_b16 a[26:27], v29 offset:24576
ds_read_b64_tr_b16 a[28:29], v30 offset:16384
ds_read_b64_tr_b16 a[30:31], v31 offset:24576
s_cmp_lg_u32 s3, 0
s_cbranch_scc1 p1c_16
ds_read_b128 a[128:131], v16 offset:0
ds_read_b128 a[132:135], v17 offset:0
ds_read_b128 a[136:139], v18 offset:0
ds_read_b128 a[140:143], v19 offset:0
ds_read_b128 a[144:147], v20 offset:0
ds_read_b128 a[148:151], v21 offset:0
ds_read_b128 a[152:155], v22 offset:0
ds_read_b128 a[156:159], v23 offset:0
ds_read_b128 a[160:163], v16 offset:256
ds_read_b128 a[164:167], v17 offset:256
ds_read_b128 a[168:171], v18 offset:256
ds_read_b128 a[172:175], v19 offset:256
ds_read_b128 a[176:179], v20 offset:256
ds_read_b128 a[180:183], v21 offset:256
ds_read_b128 a[184:187], v22 offset:256
ds_read_b128 a[188:191], v23 offset:256
ds_read_b128 a[192:195], v16 offset:512
ds_read_b128 a[196:199], v17 offset:512
ds_read_b128 a[200:203], v18 offset:512
ds_read_b128 a[204:207], v19 offset:512
ds_read_b128 a[208:211], v20 offset:512
ds_read_b128 a[212:215], v21 offset:512
ds_read_b128 a[216:219], v22 offset:512
ds_read_b128 a[220:223], v23 offset:512
ds_read_b128 a[224:227], v16 offset:768
ds_read_b128 a[228:231], v17 offset:768
ds_read_b128 a[232:235], v18 offset:768
ds_read_b128 a[236:239], v19 offset:768
ds_read_b128 a[240:243], v20 offset:768
ds_read_b128 a[244:247], v21 offset:768
ds_read_b128 a[248:251], v22 offset:768
ds_read_b128 a[252:255], v23 offset:768
p1c_16:
s_waitcnt vmcnt(17)
s_barrier
ds_read_b64_tr_b16 a[32:33], v24 offset:32768
ds_read_b64_tr_b16 a[34:35], v25 offset:40960
ds_read_b64_tr_b16 a[36:37], v26 offset:32768
ds_read_b64_tr_b16 a[38:39], v27 offset:40960
ds_read_b64_tr_b16 a[40:41], v28 offset:32768
ds_read_b64_tr_b16 a[42:43], v29 offset:40960
ds_read_b64_tr_b16 a[44:45], v30 offset:32768
ds_read_b64_tr_b16 a[46:47], v31 offset:40960
ds_read_b64_tr_b16 a[48:49], v24 offset:49152
ds_read_b64_tr_b16 a[50:51], v25 offset:57344
ds_read_b64_tr_b16 a[52:53], v26 offset:49152
ds_read_b64_tr_b16 a[54:55], v27 offset:57344
ds_read_b64_tr_b16 a[56:57], v28 offset:49152
ds_read_b64_tr_b16 a[58:59], v29 offset:57344
ds_read_b64_tr_b16 a[60:61], v30 offset:49152
ds_read_b64_tr_b16 a[62:63], v31 offset:57344
s_cmp_lg_u32 s3, 1
s_cbranch_scc1 p1c_17
ds_read_b128 a[128:131], v16 offset:0
ds_read_b128 a[132:135], v17 offset:0
ds_read_b128 a[136:139], v18 offset:0
ds_read_b128 a[140:143], v19 offset:0
ds_read_b128 a[144:147], v20 offset:0
ds_read_b128 a[148:151], v21 offset:0
ds_read_b128 a[152:155], v22 offset:0
ds_read_b128 a[156:159], v23 offset:0
ds_read_b128 a[160:163], v16 offset:256
ds_read_b128 a[164:167], v17 offset:256
ds_read_b128 a[168:171], v18 offset:256
ds_read_b128 a[172:175], v19 offset:256
ds_read_b128 a[176:179], v20 offset:256
ds_read_b128 a[180:183], v21 offset:256
ds_read_b128 a[184:187], v22 offset:256
ds_read_b128 a[188:191], v23 offset:256
ds_read_b128 a[192:195], v16 offset:512
ds_read_b128 a[196:199], v17 offset:512
ds_read_b128 a[200:203], v18 offset:512
ds_read_b128 a[204:207], v19 offset:512
ds_read_b128 a[208:211], v20 offset:512
ds_read_b128 a[212:215], v21 offset:512
ds_read_b128 a[216:219], v22 offset:512
ds_read_b128 a[220:223], v23 offset:512
ds_read_b128 a[224:227], v16 offset:768
ds_read_b128 a[228:231], v17 offset:768
ds_read_b128 a[232:235], v18 offset:768
ds_read_b128 a[236:239], v19 offset:768
ds_read_b128 a[240:243], v20 offset:768
ds_read_b128 a[244:247], v21 offset:768
ds_read_b128 a[248:251], v22 offset:768
ds_read_b128 a[252:255], v23 offset:768
p1c_17:
s_waitcnt vmcnt(9)
s_barrier
ds_read_b64_tr_b16 a[64:65], v32 offset:0
ds_read_b64_tr_b16 a[66:67], v33 offset:8192
ds_read_b64_tr_b16 a[68:69], v34 offset:0
ds_read_b64_tr_b16 a[70:71], v35 offset:8192
ds_read_b64_tr_b16 a[72:73], v36 offset:0
ds_read_b64_tr_b16 a[74:75], v37 offset:8192
ds_read_b64_tr_b16 a[76:77], v38 offset:0
ds_read_b64_tr_b16 a[78:79], v39 offset:8192
ds_read_b64_tr_b16 a[80:81], v32 offset:16384
ds_read_b64_tr_b16 a[82:83], v33 offset:24576
ds_read_b64_tr_b16 a[84:85], v34 offset:16384
ds_read_b64_tr_b16 a[86:87], v35 offset:24576
ds_read_b64_tr_b16 a[88:89], v36 offset:16384
ds_read_b64_tr_b16 a[90:91], v37 offset:24576
ds_read_b64_tr_b16 a[92:93], v38 offset:16384
ds_read_b64_tr_b16 a[94:95], v39 offset:24576
s_cmp_lg_u32 s3, 2
s_cbranch_scc1 p1c_18
ds_read_b128 a[128:131], v16 offset:0
ds_read_b128 a[132:135], v17 offset:0
ds_read_b128 a[136:139], v18 offset:0
ds_read_b128 a[140:143], v19 offset:0
ds_read_b128 a[144:147], v20 offset:0
ds_read_b128 a[148:151], v21 offset:0
ds_read_b128 a[152:155], v22 offset:0
ds_read_b128 a[156:159], v23 offset:0
ds_read_b128 a[160:163], v16 offset:256
ds_read_b128 a[164:167], v17 offset:256
ds_read_b128 a[168:171], v18 offset:256
ds_read_b128 a[172:175], v19 offset:256
ds_read_b128 a[176:179], v20 offset:256
ds_read_b128 a[180:183], v21 offset:256
ds_read_b128 a[184:187], v22 offset:256
ds_read_b128 a[188:191], v23 offset:256
ds_read_b128 a[192:195], v16 offset:512
ds_read_b128 a[196:199], v17 offset:512
ds_read_b128 a[200:203], v18 offset:512
ds_read_b128 a[204:207], v19 offset:512
ds_read_b128 a[208:211], v20 offset:512
ds_read_b128 a[212:215], v21 offset:512
ds_read_b128 a[216:219], v22 offset:512
ds_read_b128 a[220:223], v23 offset:512
ds_read_b128 a[224:227], v16 offset:768
ds_read_b128 a[228:231], v17 offset:768
ds_read_b128 a[232:235], v18 offset:768
ds_read_b128 a[236:239], v19 offset:768
ds_read_b128 a[240:243], v20 offset:768
ds_read_b128 a[244:247], v21 offset:768
ds_read_b128 a[248:251], v22 offset:768
ds_read_b128 a[252:255], v23 offset:768
p1c_18:
s_waitcnt vmcnt(0)
v_cmp_ne_u32 vcc, 16, v47
s_cbranch_vccz L_A_c0
s_mov_b32 s64, 100000
s_branch plf_21
pl_19:
s_sleep 4
plf_21:
buffer_load_dword v47, v12, s[8:11], 0 offen sc1
s_sub_u32 s64, s64, 1
s_cmp_eq_u32 s64, 0
s_waitcnt vmcnt(0)
s_cbranch_scc1 ple_20
v_cmp_ne_u32 vcc, 16, v47
s_cbranch_vccnz pl_19
ple_20:
L_A_c0:
buffer_load_dwordx4 v[176:179], v4, s[4:7], s78 offen offset:0 sc1
buffer_load_dwordx4 v[180:183], v4, s[4:7], s78 offen offset:1024 sc1
buffer_load_dwordx4 v[184:187], v4, s[4:7], s78 offen offset:2048 sc1
buffer_load_dwordx4 v[188:191], v4, s[4:7], s78 offen offset:3072 sc1
buffer_load_dwordx4 v[192:195], v4, s[4:7], s67 offen offset:0 sc1
buffer_load_dwordx4 v[196:199], v4, s[4:7], s67 offen offset:1024 sc1
buffer_load_dwordx4 v[200:203], v4, s[4:7], s67 offen offset:2048 sc1
buffer_load_dwordx4 v[204:207], v4, s[4:7], s67 offen offset:3072 sc1
s_barrier
ds_read_b64_tr_b16 a[96:97], v32 offset:32768
ds_read_b64_tr_b16 a[98:99], v33 offset:40960
ds_read_b64_tr_b16 a[100:101], v34 offset:32768
ds_read_b64_tr_b16 a[102:103], v35 offset:40960
ds_read_b64_tr_b16 a[104:105], v36 offset:32768
ds_read_b64_tr_b16 a[106:107], v37 offset:40960
ds_read_b64_tr_b16 a[108:109], v38 offset:32768
ds_read_b64_tr_b16 a[110:111], v39 offset:40960
ds_read_b64_tr_b16 a[112:113], v32 offset:49152
ds_read_b64_tr_b16 a[114:115], v33 offset:57344
ds_read_b64_tr_b16 a[116:117], v34 offset:49152
ds_read_b64_tr_b16 a[118:119], v35 offset:57344
ds_read_b64_tr_b16 a[120:121], v36 offset:49152
ds_read_b64_tr_b16 a[122:123], v37 offset:57344
ds_read_b64_tr_b16 a[124:125], v38 offset:49152
ds_read_b64_tr_b16 a[126:127], v39 offset:57344
s_cmp_lg_u32 s3, 3
s_cbranch_scc1 p1c_22
ds_read_b128 a[128:131], v16 offset:0
ds_read_b128 a[132:135], v17 offset:0
ds_read_b128 a[136:139], v18 offset:0
ds_read_b128 a[140:143], v19 offset:0
ds_read_b128 a[144:147], v20 offset:0
ds_read_b128 a[148:151], v21 offset:0
ds_read_b128 a[152:155], v22 offset:0
ds_read_b128 a[156:159], v23 offset:0
ds_read_b128 a[160:163], v16 offset:256
ds_read_b128 a[164:167], v17 offset:256
ds_read_b128 a[168:171], v18 offset:256
ds_read_b128 a[172:175], v19 offset:256
ds_read_b128 a[176:179], v20 offset:256
ds_read_b128 a[180:183], v21 offset:256
ds_read_b128 a[184:187], v22 offset:256
ds_read_b128 a[188:191], v23 offset:256
ds_read_b128 a[192:195], v16 offset:512
ds_read_b128 a[196:199], v17 offset:512
ds_read_b128 a[200:203], v18 offset:512
ds_read_b128 a[204:207], v19 offset:512
ds_read_b128 a[208:211], v20 offset:512
ds_read_b128 a[212:215], v21 offset:512
ds_read_b128 a[216:219], v22 offset:512
ds_read_b128 a[220:223], v23 offset:512
ds_read_b128 a[224:227], v16 offset:768
ds_read_b128 a[228:231], v17 offset:768
ds_read_b128 a[232:235], v18 offset:768
ds_read_b128 a[236:239], v19 offset:768
ds_read_b128 a[240:243], v20 offset:768
ds_read_b128 a[244:247], v21 offset:768
ds_read_b128 a[248:251], v22 offset:768
ds_read_b128 a[252:255], v23 offset:768
p1c_22:
s_waitcnt vmcnt(7)
ds_write_b128 v168, v[176:179] offset:0
v_max3_u32 v9, v176, v177, v178
v_max_u32 v9, v9, v179
s_waitcnt vmcnt(6)
ds_write_b128 v169, v[180:183] offset:1024
v_max3_u32 v9, v9, v180, v181
v_max3_u32 v9, v9, v182, v183
s_waitcnt vmcnt(5)
ds_write_b128 v170, v[184:187] offset:2048
v_max3_u32 v9, v9, v184, v185
v_max3_u32 v9, v9, v186, v187
s_waitcnt vmcnt(4)
ds_write_b128 v171, v[188:191] offset:3072
v_max3_u32 v9, v9, v188, v189
v_max3_u32 v9, v9, v190, v191
s_waitcnt vmcnt(3)
ds_write_b128 v172, v[192:195] offset:4096
v_max3_u32 v9, v9, v192, v193
v_max3_u32 v9, v9, v194, v195
s_waitcnt vmcnt(2)
ds_write_b128 v173, v[196:199] offset:5120
v_max3_u32 v9, v9, v196, v197
v_max3_u32 v9, v9, v198, v199
s_waitcnt vmcnt(1)
ds_write_b128 v174, v[200:203] offset:6144
v_max3_u32 v9, v9, v200, v201
v_max3_u32 v9, v9, v202, v203
s_waitcnt vmcnt(0)
ds_write_b128 v175, v[204:207] offset:7168
v_max3_u32 v9, v9, v204, v205
v_max3_u32 v9, v9, v206, v207
v_cmp_eq_u32 vcc, -1, v9
s_cbranch_vccz L_A_gok
s_mov_b32 s64, 100000
L_A_g0:
s_waitcnt lgkmcnt(0)
buffer_load_dwordx4 v[176:179], v4, s[4:7], s78 offen offset:0 sc1
buffer_load_dwordx4 v[180:183], v4, s[4:7], s78 offen offset:1024 sc1
buffer_load_dwordx4 v[184:187], v4, s[4:7], s78 offen offset:2048 sc1
buffer_load_dwordx4 v[188:191], v4, s[4:7], s78 offen offset:3072 sc1
buffer_load_dwordx4 v[192:195], v4, s[4:7], s67 offen offset:0 sc1
buffer_load_dwordx4 v[196:199], v4, s[4:7], s67 offen offset:1024 sc1
buffer_load_dwordx4 v[200:203], v4, s[4:7], s67 offen offset:2048 sc1
buffer_load_dwordx4 v[204:207], v4, s[4:7], s67 offen offset:3072 sc1
s_waitcnt vmcnt(7)
ds_write_b128 v168, v[176:179] offset:0
v_max3_u32 v9, v176, v177, v178
v_max_u32 v9, v9, v179
s_waitcnt vmcnt(6)
ds_write_b128 v169, v[180:183] offset:1024
v_max3_u32 v9, v9, v180, v181
v_max3_u32 v9, v9, v182, v183
s_waitcnt vmcnt(5)
ds_write_b128 v170, v[184:187] offset:2048
v_max3_u32 v9, v9, v184, v185
v_max3_u32 v9, v9, v186, v187
s_waitcnt vmcnt(4)
ds_write_b128 v171, v[188:191] offset:3072
v_max3_u32 v9, v9, v188, v189
v_max3_u32 v9, v9, v190, v191
s_waitcnt vmcnt(3)
ds_write_b128 v172, v[192:195] offset:4096
v_max3_u32 v9, v9, v192, v193
v_max3_u32 v9, v9, v194, v195
s_waitcnt vmcnt(2)
ds_write_b128 v173, v[196:199] offset:5120
v_max3_u32 v9, v9, v196, v197
v_max3_u32 v9, v9, v198, v199
s_waitcnt vmcnt(1)
ds_write_b128 v174, v[200:203] offset:6144
v_max3_u32 v9, v9, v200, v201
v_max3_u32 v9, v9, v202, v203
s_waitcnt vmcnt(0)
ds_write_b128 v175, v[204:207] offset:7168
v_max3_u32 v9, v9, v204, v205
v_max3_u32 v9, v9, v206, v207
v_cmp_eq_u32 vcc, -1, v9
s_sub_u32 s64, s64, 1
s_cmp_eq_u32 s64, 0
s_cbranch_scc1 L_A_gok
s_cbranch_vccnz L_A_g0
L_A_gok:
s_waitcnt lgkmcnt(0)
s_barrier
ds_read_b128 v[224:227], v128 offset:0
ds_read_b128 v[228:231], v129 offset:0
ds_read_b128 v[232:235], v130 offset:0
ds_read_b128 v[236:239], v131 offset:0
ds_read_b128 v[240:243], v132 offset:0
ds_read_b128 v[244:247], v133 offset:0
ds_read_b128 v[248:251], v134 offset:0
s_add_u32 m0, s77, 0
s_nop 0
buffer_load_dwordx4 v160, s[12:15], s76 offen offset:0  lds
buffer_load_dwordx4 v161, s[12:15], s76 offen offset:1024  lds
buffer_load_dwordx4 v162, s[12:15], s76 offen offset:2048  lds
buffer_load_dwordx4 v163, s[12:15], s76 offen offset:3072  lds
s_addk_i32 m0, 0x1000
s_nop 0
buffer_load_dwordx4 v164, s[12:15], s76 offen offset:0  lds
buffer_load_dwordx4 v165, s[12:15], s76 offen offset:1024  lds
buffer_load_dwordx4 v166, s[12:15], s76 offen offset:2048  lds
buffer_load_dwordx4 v167, s[12:15], s76 offen offset:3072  lds
s_add_u32 s69, s76, 360448
s_and_b32 s69, s69, 0xfffff
s_andn2_b32 s76, s76, 0xfffff
s_or_b32 s76, s76, s69
s_add_u32 s76, s76, 1048576
s_waitcnt lgkmcnt(6)
v_mfma_f32_32x32x16_bf16 v[48:63], a[128:131], v[224:227], 0
ds_read_b128 v[252:255], v135 offset:0
s_waitcnt lgkmcnt(6)
v_mfma_f32_32x32x16_bf16 v[48:63], a[132:135], v[228:231], v[48:63]
ds_read_b128 a[128:131], v128 offset:256
s_waitcnt lgkmcnt(6)
v_mfma_f32_32x32x16_bf16 v[48:63], a[136:139], v[232:235], v[48:63]
ds_read_b128 a[132:135], v129 offset:256
s_add_u32 m0, s77, 32768
s_nop 0
buffer_load_dwordx4 v160, s[12:15], s76 offen offset:0  lds
s_waitcnt lgkmcnt(6)
v_mfma_f32_32x32x16_bf16 v[48:63], a[140:143], v[236:239], v[48:63]
ds_read_b128 a[136:139], v130 offset:256
s_waitcnt lgkmcnt(6)
v_mfma_f32_32x32x16_bf16 v[48:63], a[144:147], v[240:243], v[48:63]
ds_read_b128 a[140:143], v131 offset:256
s_waitcnt lgkmcnt(6)
v_mfma_f32_32x32x16_bf16 v[48:63], a[148:151], v[244:247], v[48:63]
ds_read_b128 a[144:147], v132 offset:256
buffer_load_dwordx4 v161, s[12:15], s76 offen offset:1024  lds
s_waitcnt lgkmcnt(6)
v_mfma_f32_32x32x16_bf16 v[48:63], a[152:155], v[248:251], v[48:63]
ds_read_b128 a[148:151], v133 offset:256
s_waitcnt lgkmcnt(6)
v_mfma_f32_32x32x16_bf16 v[48:63], a[156:159], v[252:255], v[48:63]
ds_read_b128 a[152:155], v134 offset:256
buffer_load_dwordx4 v162, s[12:15], s76 offen offset:2048  lds
s_waitcnt lgkmcnt(6)
v_mfma_f32_32x32x16_bf16 v[48:63], a[160:163], a[128:131], v[48:63]
ds_read_b128 a[156:159], v135 offset:256
s_waitcnt lgkmcnt(6)
v_mfma_f32_32x32x16_bf16 v[48:63], a[164:167], a[132:135], v[48:63]
ds_read_b128 a[160:163], v128 offset:512
s_waitcnt lgkmcnt(6)
v_mfma_f32_32x32x16_bf16 v[48:63], a[168:171], a[136:139], v[48:63]
ds_read_b128 a[164:167], v129 offset:512
buffer_load_dwordx4 v163, s[12:15], s76 offen offset:3072  lds
s_waitcnt lgkmcnt(6)
v_mfma_f32_32x32x16_bf16 v[48:63], a[172:175], a[140:143], v[48:63]
ds_read_b128 a[168:171], v130 offset:512
s_waitcnt lgkmcnt(6)
v_mfma_f32_32x32x16_bf16 v[48:63], a[176:179], a[144:147], v[48:63]
ds_read_b128 a[172:175], v131 offset:512
s_waitcnt lgkmcnt(6)
v_mfma_f32_32x32x16_bf16 v[48:63], a[180:183], a[148:151], v[48:63]
ds_read_b128 a[176:179], v132 offset:512
s_addk_i32 m0, 0x1000
s_nop 0
buffer_load_dwordx4 v164, s[12:15], s76 offen offset:0  lds
s_waitcnt lgkmcnt(6)
v_mfma_f32_32x32x16_bf16 v[48:63], a[184:187], a[152:155], v[48:63]
ds_read_b128 a[180:183], v133 offset:512
s_waitcnt lgkmcnt(6)
v_mfma_f32_32x32x16_bf16 v[48:63], a[188:191], a[156:159], v[48:63]
ds_read_b128 a[184:187], v134 offset:512
buffer_load_dwordx4 v165, s[12:15], s76 offen offset:1024  lds
s_waitcnt lgkmcnt(6)
v_mfma_f32_32x32x16_bf16 v[48:63], a[192:195], a[160:163], v[48:63]
ds_read_b128 a[188:191], v135 offset:512
s_waitcnt lgkmcnt(6)
v_mfma_f32_32x32x16_bf16 v[48:63], a[196:199], a[164:167], v[48:63]
ds_read_b128 a[192:195], v128 offset:768
s_waitcnt lgkmcnt(6)
v_mfma_f32_32x32x16_bf16 v[48:63], a[200:203], a[168:171], v[48:63]
ds_read_b128 a[196:199], v129 offset:768
buffer_load_dwordx4 v166, s[12:15], s76 offen offset:2048  lds
s_waitcnt lgkmcnt(6)
v_mfma_f32_32x32x16_bf16 v[48:63], a[204:207], a[172:175], v[48:63]
ds_read_b128 a[200:203], v130 offset:768
s_waitcnt lgkmcnt(6)
v_mfma_f32_32x32x16_bf16 v[48:63], a[208:211], a[176:179], v[48:63]
ds_read_b128 a[204:207], v131 offset:768
s_waitcnt lgkmcnt(6)
v_mfma_f32_32x32x16_bf16 v[48:63], a[212:215], a[180:183], v[48:63]
ds_read_b128 a[208:211], v132 offset:768
buffer_load_dwordx4 v167, s[12:15], s76 offen offset:3072  lds
s_add_u32 s69, s76, 360448
s_and_b32 s69, s69, 0xfffff
s_andn2_b32 s76, s76, 0xfffff
s_or_b32 s76, s76, s69
s_add_u32 s76, s76, 1048576
s_waitcnt lgkmcnt(6)
v_mfma_f32_32x32x16_bf16 v[48:63], a[216:219], a[184:187], v[48:63]
ds_read_b128 a[212:215], v133 offset:768
s_waitcnt lgkmcnt(6)
v_mfma_f32_32x32x16_bf16 v[48:63], a[220:223], a[188:191], v[48:63]
ds_read_b128 a[216:219], v134 offset:768
s_add_u32 m0, s77, 65536
s_nop 0
buffer_load_dwordx4 v160, s[12:15], s76 offen offset:0  lds
s_waitcnt lgkmcnt(6)
v_mfma_f32_32x32x16_bf16 v[48:63], a[224:227], a[192:195], v[48:63]
ds_read_b128 a[220:223], v135 offset:768
s_waitcnt lgkmcnt(6)
v_mfma_f32_32x32x16_bf16 v[48:63], a[228:231], a[196:199], v[48:63]
s_waitcnt lgkmcnt(5)
v_mfma_f32_32x32x16_bf16 v[48:63], a[232:235], a[200:203], v[48:63]
buffer_load_dwordx4 v161, s[12:15], s76 offen offset:1024  lds
s_waitcnt lgkmcnt(4)
v_mfma_f32_32x32x16_bf16 v[48:63], a[236:239], a[204:207], v[48:63]
s_waitcnt lgkmcnt(3)
v_mfma_f32_32x32x16_bf16 v[48:63], a[240:243], a[208:211], v[48:63]
s_waitcnt lgkmcnt(2)
v_mfma_f32_32x32x16_bf16 v[48:63], a[244:247], a[212:215], v[48:63]
buffer_load_dwordx4 v162, s[12:15], s76 offen offset:2048  lds
s_waitcnt lgkmcnt(1)
v_mfma_f32_32x32x16_bf16 v[48:63], a[248:251], a[216:219], v[48:63]
s_waitcnt lgkmcnt(0)
v_mfma_f32_32x32x16_bf16 v[48:63], a[252:255], a[220:223], v[48:63]
buffer_load_dwordx4 v163, s[12:15], s76 offen offset:3072  lds
s_addk_i32 m0, 0x1000
s_nop 0
buffer_load_dwordx4 v164, s[12:15], s76 offen offset:0  lds
buffer_load_dwordx4 v165, s[12:15], s76 offen offset:1024  lds
buffer_load_dwordx4 v166, s[12:15], s76 offen offset:2048  lds
buffer_load_dwordx4 v167, s[12:15], s76 offen offset:3072  lds
s_add_u32 s69, s76, 360448
s_and_b32 s69, s69, 0xfffff
s_andn2_b32 s76, s76, 0xfffff
s_or_b32 s76, s76, s69
s_add_u32 s76, s76, 1048576
s_nop 0
v_max3_f32 v8, v48, v49, v50
v_max3_f32 v9, v51, v52, v53
v_max3_f32 v10, v54, v55, v56
v_max3_f32 v11, v57, v58, v59
v_max3_f32 v8, v8, v60, v61
v_max3_f32 v9, v9, v62, v63
v_max_f32 v10, v10, v11
v_max3_f32 v8, v8, v9, v10
v_ceil_f32 v216, v8
v_sub_f32 v48, v48, v216
v_sub_f32 v49, v49, v216
v_sub_f32 v50, v50, v216
v_sub_f32 v51, v51, v216
v_sub_f32 v52, v52, v216
v_sub_f32 v53, v53, v216
v_sub_f32 v54, v54, v216
v_sub_f32 v55, v55, v216
v_exp_f32 v48, v48
v_exp_f32 v49, v49
v_exp_f32 v50, v50
v_exp_f32 v51, v51
v_exp_f32 v52, v52
v_exp_f32 v53, v53
v_exp_f32 v54, v54
v_exp_f32 v55, v55
s_barrier
ds_write_b32 v41, v216 offset:0
v_cvt_pk_bf16_f32 v168, v48, v49
v_cvt_pk_bf16_f32 v169, v50, v51
v_cvt_pk_bf16_f32 v170, v52, v53
v_cvt_pk_bf16_f32 v171, v54, v55
ds_write_b128 v43, v[168:171] offset:0
v_sub_f32 v56, v56, v216
v_sub_f32 v57, v57, v216
v_sub_f32 v58, v58, v216
v_sub_f32 v59, v59, v216
v_sub_f32 v60, v60, v216
v_sub_f32 v61, v61, v216
v_sub_f32 v62, v62, v216
v_sub_f32 v63, v63, v216
v_exp_f32 v56, v56
v_exp_f32 v57, v57
v_exp_f32 v58, v58
v_exp_f32 v59, v59
v_exp_f32 v60, v60
v_exp_f32 v61, v61
v_exp_f32 v62, v62
v_exp_f32 v63, v63
v_cvt_pk_bf16_f32 v172, v56, v57
v_cvt_pk_bf16_f32 v173, v58, v59
v_cvt_pk_bf16_f32 v174, v60, v61
v_cvt_pk_bf16_f32 v175, v62, v63
ds_write_b128 v43, v[172:175] offset:1024
s_add_u32 m0, s77, 98304
s_nop 0
buffer_load_dwordx4 v160, s[12:15], s76 offen offset:0  lds
buffer_load_dwordx4 v161, s[12:15], s76 offen offset:1024  lds
buffer_load_dwordx4 v162, s[12:15], s76 offen offset:2048  lds
buffer_load_dwordx4 v163, s[12:15], s76 offen offset:3072  lds
s_waitcnt lgkmcnt(0)
s_barrier
ds_read_b128 v[12:15], v40
ds_read_b128 v[168:171], v46
ds_read_b128 v[128:131], v42 offset:0
ds_read_b128 v[132:135], v42 offset:1024
ds_read_b128 v[136:139], v42 offset:2048
ds_read_b128 v[140:143], v42 offset:3072
ds_read_b128 v[144:147], v42 offset:4096
ds_read_b128 v[148:151], v42 offset:5120
ds_read_b128 v[152:155], v42 offset:6144
ds_read_b128 v[156:159], v42 offset:7168
v_add_f32 v48, v48, v56
v_add_f32 v49, v49, v57
v_add_f32 v50, v50, v58
v_add_f32 v51, v51, v59
v_add_f32 v52, v52, v60
v_add_f32 v53, v53, v61
v_add_f32 v54, v54, v62
v_add_f32 v55, v55, v63
v_add_f32 v48, v48, v52
v_add_f32 v49, v49, v53
v_add_f32 v50, v50, v54
v_add_f32 v51, v51, v55
v_add_f32 v48, v48, v50
v_add_f32 v49, v49, v51
v_add_f32 v217, v48, v49
s_waitcnt lgkmcnt(8)
v_max3_f32 v9, v12, v13, v14
v_max3_f32 v10, v169, v170, v171
v_max3_f32 v9, v9, v15, v168
v_max_f32 v44, v9, v10
v_sub_f32 v12, v44, v12
v_cvt_u32_f32 v8, v12
v_min_u32 v8, 0xff, v8
v_mul_u32_u24 v8, 0x800080, v8
s_waitcnt lgkmcnt(7)
v_pk_sub_u16 v128, v128, v8 clamp
v_pk_sub_u16 v129, v129, v8 clamp
v_pk_sub_u16 v130, v130, v8 clamp
v_pk_sub_u16 v131, v131, v8 clamp
s_waitcnt lgkmcnt(6)
v_pk_sub_u16 v132, v132, v8 clamp
v_pk_sub_u16 v133, v133, v8 clamp
v_pk_sub_u16 v134, v134, v8 clamp
v_pk_sub_u16 v135, v135, v8 clamp
s_nop 1
v_mfma_f32_32x32x16_bf16 v[64:79], a[0:3], v[128:131], 0
v_sub_f32 v13, v44, v13
v_cvt_u32_f32 v9, v13
v_min_u32 v9, 0xff, v9
v_mul_u32_u24 v9, 0x800080, v9
s_waitcnt lgkmcnt(5)
v_pk_sub_u16 v136, v136, v9 clamp
v_pk_sub_u16 v137, v137, v9 clamp
s_addk_i32 m0, 0x1000
s_nop 0
buffer_load_dwordx4 v164, s[12:15], s76 offen offset:0  lds
v_mfma_f32_32x32x16_bf16 v[64:79], a[16:19], v[132:135], v[64:79]
v_pk_sub_u16 v138, v138, v9 clamp
v_pk_sub_u16 v139, v139, v9 clamp
s_waitcnt lgkmcnt(4)
v_pk_sub_u16 v140, v140, v9 clamp
v_pk_sub_u16 v141, v141, v9 clamp
v_pk_sub_u16 v142, v142, v9 clamp
v_pk_sub_u16 v143, v143, v9 clamp
buffer_load_dwordx4 v165, s[12:15], s76 offen offset:1024  lds
v_mfma_f32_32x32x16_bf16 v[64:79], a[32:35], v[136:139], v[64:79]
v_sub_f32 v14, v44, v14
v_cvt_u32_f32 v10, v14
v_min_u32 v10, 0xff, v10
v_mul_u32_u24 v10, 0x800080, v10
s_waitcnt lgkmcnt(3)
v_pk_sub_u16 v144, v144, v10 clamp
v_pk_sub_u16 v145, v145, v10 clamp
buffer_load_dwordx4 v166, s[12:15], s76 offen offset:2048  lds
v_mfma_f32_32x32x16_bf16 v[64:79], a[48:51], v[140:143], v[64:79]
v_pk_sub_u16 v146, v146, v10 clamp
v_pk_sub_u16 v147, v147, v10 clamp
s_waitcnt lgkmcnt(2)
v_pk_sub_u16 v148, v148, v10 clamp
v_pk_sub_u16 v149, v149, v10 clamp
v_pk_sub_u16 v150, v150, v10 clamp
v_pk_sub_u16 v151, v151, v10 clamp
buffer_load_dwordx4 v167, s[12:15], s76 offen offset:3072  lds
s_add_u32 s69, s76, 360448
s_and_b32 s69, s69, 0xfffff
s_andn2_b32 s76, s76, 0xfffff
s_or_b32 s76, s76, s69
s_add_u32 s76, s76, 1048576
v_mfma_f32_32x32x16_bf16 v[64:79], a[64:67], v[144:147], v[64:79]
v_sub_f32 v15, v44, v15
v_cvt_u32_f32 v11, v15
v_min_u32 v11, 0xff, v11
v_mul_u32_u24 v11, 0x800080, v11
s_waitcnt lgkmcnt(1)
v_pk_sub_u16 v152, v152, v11 clamp
v_pk_sub_u16 v153, v153, v11 clamp
v_mfma_f32_32x32x16_bf16 v[64:79], a[80:83], v[148:151], v[64:79]
v_pk_sub_u16 v154, v154, v11 clamp
v_pk_sub_u16 v155, v155, v11 clamp
s_waitcnt lgkmcnt(0)
v_pk_sub_u16 v156, v156, v11 clamp
v_pk_sub_u16 v157, v157, v11 clamp
v_pk_sub_u16 v158, v158, v11 clamp
v_pk_sub_u16 v159, v159, v11 clamp
v_mfma_f32_32x32x16_bf16 v[64:79], a[96:99], v[152:155], v[64:79]
v_sub_f32 v216, v216, v44
v_exp_f32 v216, v216
v_add_f32 v47, 0x41f00000, v44
v_mul_f32 v217, v217, v216
v_mfma_f32_32x32x16_bf16 v[64:79], a[112:115], v[156:159], v[64:79]
v_mfma_f32_32x32x16_bf16 v[80:95], a[4:7], v[128:131], 0
v_mfma_f32_32x32x16_bf16 v[80:95], a[20:23], v[132:135], v[80:95]
v_mfma_f32_32x32x16_bf16 v[80:95], a[36:39], v[136:139], v[80:95]
v_mfma_f32_32x32x16_bf16 v[80:95], a[52:55], v[140:143], v[80:95]
v_mfma_f32_32x32x16_bf16 v[80:95], a[68:71], v[144:147], v[80:95]
v_mfma_f32_32x32x16_bf16 v[80:95], a[84:87], v[148:151], v[80:95]
v_mfma_f32_32x32x16_bf16 v[80:95], a[100:103], v[152:155], v[80:95]
v_mfma_f32_32x32x16_bf16 v[80:95], a[116:119], v[156:159], v[80:95]
s_waitcnt vmcnt(0)
s_barrier
ds_read_b128 v[176:179], v16 offset:0
ds_read_b128 v[180:183], v17 offset:0
ds_read_b128 v[184:187], v18 offset:0
ds_read_b128 v[188:191], v19 offset:0
ds_read_b128 v[192:195], v20 offset:0
ds_read_b128 v[196:199], v21 offset:0
s_waitcnt lgkmcnt(5)
v_mfma_f32_32x32x16_bf16 v[48:63], v[176:179], v[224:227], 0
ds_read_b128 v[200:203], v22 offset:0
ds_read_b64_tr_b16 a[0:1], v24 offset:0
ds_read_b64_tr_b16 a[2:3], v25 offset:8192
s_waitcnt lgkmcnt(7)
v_mfma_f32_32x32x16_bf16 v[48:63], v[180:183], v[228:231], v[48:63]
ds_read_b128 v[204:207], v23 offset:0
buffer_load_dword v223, v218, s[44:47], s70 offen
s_waitcnt lgkmcnt(7)
v_mfma_f32_32x32x16_bf16 v[48:63], v[184:187], v[232:235], v[48:63]
ds_read_b128 v[176:179], v16 offset:256
ds_read_b64_tr_b16 a[16:17], v24 offset:16384
ds_read_b64_tr_b16 a[18:19], v25 offset:24576
s_waitcnt lgkmcnt(9)
v_mfma_f32_32x32x16_bf16 v[48:63], v[188:191], v[236:239], v[48:63]
ds_read_b128 v[180:183], v17 offset:256
ds_read_b64_tr_b16 a[32:33], v24 offset:32768
ds_read_b64_tr_b16 a[34:35], v25 offset:40960
s_waitcnt lgkmcnt(11)
v_mfma_f32_32x32x16_bf16 v[48:63], v[192:195], v[240:243], v[48:63]
ds_read_b128 v[184:187], v18 offset:256
buffer_load_dword v223, v218, s[48:51], s70 offen
s_waitcnt lgkmcnt(11)
v_mfma_f32_32x32x16_bf16 v[48:63], v[196:199], v[244:247], v[48:63]
ds_read_b128 v[188:191], v19 offset:256
ds_read_b64_tr_b16 a[48:49], v24 offset:49152
ds_read_b64_tr_b16 a[50:51], v25 offset:57344
s_waitcnt lgkmcnt(13)
v_mfma_f32_32x32x16_bf16 v[48:63], v[200:203], v[248:251], v[48:63]
ds_read_b128 v[192:195], v20 offset:256
ds_read_b64_tr_b16 a[64:65], v32 offset:0
ds_read_b64_tr_b16 a[66:67], v33 offset:8192
s_waitcnt lgkmcnt(13)
v_mfma_f32_32x32x16_bf16 v[48:63], v[204:207], v[252:255], v[48:63]
ds_read_b128 v[196:199], v21 offset:256
buffer_load_dword v223, v219, s[52:55], s71 offen
s_waitcnt lgkmcnt(13)
v_mfma_f32_32x32x16_bf16 v[48:63], v[176:179], a[128:131], v[48:63]
ds_read_b128 v[200:203], v22 offset:256
ds_read_b64_tr_b16 a[80:81], v32 offset:16384
ds_read_b64_tr_b16 a[82:83], v33 offset:24576
s_waitcnt lgkmcnt(13)
v_mfma_f32_32x32x16_bf16 v[48:63], v[180:183], a[132:135], v[48:63]
ds_read_b128 v[204:207], v23 offset:256
ds_read_b64_tr_b16 a[96:97], v32 offset:32768
ds_read_b64_tr_b16 a[98:99], v33 offset:40960
s_waitcnt lgkmcnt(13)
v_mfma_f32_32x32x16_bf16 v[48:63], v[184:187], a[136:139], v[48:63]
ds_read_b128 v[176:179], v16 offset:512
ds_read_b64_tr_b16 a[112:113], v32 offset:49152
ds_read_b64_tr_b16 a[114:115], v33 offset:57344
s_waitcnt lgkmcnt(14)
v_mfma_f32_32x32x16_bf16 v[48:63], v[188:191], a[140:143], v[48:63]
ds_read_b128 v[180:183], v17 offset:512
ds_read_b64_tr_b16 a[4:5], v26 offset:0
ds_read_b64_tr_b16 a[6:7], v27 offset:8192
s_waitcnt lgkmcnt(14)
v_mfma_f32_32x32x16_bf16 v[48:63], v[192:195], a[144:147], v[48:63]
ds_read_b128 v[184:187], v18 offset:512
ds_read_b64_tr_b16 a[20:21], v26 offset:16384
ds_read_b64_tr_b16 a[22:23], v27 offset:24576
s_waitcnt lgkmcnt(14)
v_mfma_f32_32x32x16_bf16 v[48:63], v[196:199], a[148:151], v[48:63]
ds_read_b128 v[188:191], v19 offset:512
ds_read_b64_tr_b16 a[36:37], v26 offset:32768
ds_read_b64_tr_b16 a[38:39], v27 offset:40960
v_mfma_f32_32x32x16_bf16 v[48:63], v[200:203], a[152:155], v[48:63]
ds_read_b128 v[192:195], v20 offset:512
ds_read_b64_tr_b16 a[52:53], v26 offset:49152
ds_read_b64_tr_b16 a[54:55], v27 offset:57344
s_waitcnt lgkmcnt(14)
v_mfma_f32_32x32x16_bf16 v[48:63], v[204:207], a[156:159], v[48:63]
ds_read_b128 v[196:199], v21 offset:512
ds_read_b64_tr_b16 a[68:69], v34 offset:0
ds_read_b64_tr_b16 a[70:71], v35 offset:8192
v_mfma_f32_32x32x16_bf16 v[48:63], v[176:179], a[160:163], v[48:63]
ds_read_b128 v[200:203], v22 offset:512
ds_read_b64_tr_b16 a[84:85], v34 offset:16384
ds_read_b64_tr_b16 a[86:87], v35 offset:24576
s_waitcnt lgkmcnt(14)
v_mfma_f32_32x32x16_bf16 v[48:63], v[180:183], a[164:167], v[48:63]
ds_read_b128 v[204:207], v23 offset:512
ds_read_b64_tr_b16 a[100:101], v34 offset:32768
ds_read_b64_tr_b16 a[102:103], v35 offset:40960
v_mfma_f32_32x32x16_bf16 v[48:63], v[184:187], a[168:171], v[48:63]
ds_read_b128 v[176:179], v16 offset:768
ds_read_b64_tr_b16 a[116:117], v34 offset:49152
ds_read_b64_tr_b16 a[118:119], v35 offset:57344
s_waitcnt lgkmcnt(14)
v_mfma_f32_32x32x16_bf16 v[48:63], v[188:191], a[172:175], v[48:63]
ds_read_b128 v[180:183], v17 offset:768
v_mfma_f32_32x32x16_bf16 v[48:63], v[192:195], a[176:179], v[48:63]
ds_read_b128 v[184:187], v18 offset:768
s_waitcnt lgkmcnt(13)
v_mfma_f32_32x32x16_bf16 v[48:63], v[196:199], a[180:183], v[48:63]
ds_read_b128 v[188:191], v19 offset:768
s_waitcnt lgkmcnt(11)
v_mfma_f32_32x32x16_bf16 v[48:63], v[200:203], a[184:187], v[48:63]
ds_read_b128 v[192:195], v20 offset:768
s_waitcnt lgkmcnt(9)
v_mfma_f32_32x32x16_bf16 v[48:63], v[204:207], a[188:191], v[48:63]
ds_read_b128 v[196:199], v21 offset:768
s_waitcnt lgkmcnt(7)
v_mfma_f32_32x32x16_bf16 v[48:63], v[176:179], a[192:195], v[48:63]
ds_read_b128 v[200:203], v22 offset:768
s_waitcnt lgkmcnt(5)
v_mfma_f32_32x32x16_bf16 v[48:63], v[180:183], a[196:199], v[48:63]
ds_read_b128 v[204:207], v23 offset:768
s_waitcnt lgkmcnt(5)
v_mfma_f32_32x32x16_bf16 v[48:63], v[184:187], a[200:203], v[48:63]
s_waitcnt lgkmcnt(4)
v_mfma_f32_32x32x16_bf16 v[48:63], v[188:191], a[204:207], v[48:63]
s_waitcnt lgkmcnt(3)
v_mfma_f32_32x32x16_bf16 v[48:63], v[192:195], a[208:211], v[48:63]
s_waitcnt lgkmcnt(2)
v_mfma_f32_32x32x16_bf16 v[48:63], v[196:199], a[212:215], v[48:63]
s_waitcnt lgkmcnt(1)
v_mfma_f32_32x32x16_bf16 v[48:63], v[200:203], a[216:219], v[48:63]
s_waitcnt lgkmcnt(0)
v_mfma_f32_32x32x16_bf16 v[48:63], v[204:207], a[220:223], v[48:63]
v_mfma_f32_32x32x16_bf16 v[96:111], a[8:11], v[128:131], 0
s_nop 2
v_mfma_f32_32x32x16_bf16 v[96:111], a[24:27], v[132:135], v[96:111]
ds_read_b64_tr_b16 a[8:9], v28 offset:0
ds_read_b64_tr_b16 a[10:11], v29 offset:8192
s_nop 0
v_mfma_f32_32x32x16_bf16 v[96:111], a[40:43], v[136:139], v[96:111]
ds_read_b64_tr_b16 a[24:25], v28 offset:16384
ds_read_b64_tr_b16 a[26:27], v29 offset:24576
s_nop 0
v_mfma_f32_32x32x16_bf16 v[96:111], a[56:59], v[140:143], v[96:111]
v_max3_f32 v8, v48, v49, v50
v_max3_f32 v9, v51, v52, v53
v_max3_f32 v10, v54, v55, v56
v_max3_f32 v11, v57, v58, v59
v_max3_f32 v8, v8, v60, v61
v_max3_f32 v9, v9, v62, v63
v_max_f32 v10, v10, v11
v_mfma_f32_32x32x16_bf16 v[96:111], a[72:75], v[144:147], v[96:111]
v_max3_f32 v8, v8, v9, v10
v_cmp_gt_f32 vcc, v8, v47
v_ceil_f32 v8, v8
s_nop 0
v_cndmask_b32 v222, v44, v8, vcc
v_sub_f32 v48, v48, v222
v_sub_f32 v49, v49, v222
v_mfma_f32_32x32x16_bf16 v[96:111], a[88:91], v[148:151], v[96:111]
v_sub_f32 v50, v50, v222
v_sub_f32 v51, v51, v222
v_sub_f32 v52, v52, v222
v_sub_f32 v53, v53, v222
v_sub_f32 v54, v54, v222
v_sub_f32 v55, v55, v222
v_exp_f32 v48, v48
v_mfma_f32_32x32x16_bf16 v[96:111], a[104:107], v[152:155], v[96:111]
v_exp_f32 v49, v49
v_exp_f32 v50, v50
v_exp_f32 v51, v51
v_exp_f32 v52, v52
v_mfma_f32_32x32x16_bf16 v[96:111], a[120:123], v[156:159], v[96:111]
v_exp_f32 v53, v53
v_exp_f32 v54, v54
v_exp_f32 v55, v55
ds_write_b32 v41, v222 offset:10240
v_mfma_f32_32x32x16_bf16 v[112:127], a[12:15], v[128:131], 0
v_cvt_pk_bf16_f32 v168, v48, v49
v_cvt_pk_bf16_f32 v169, v50, v51
v_cvt_pk_bf16_f32 v170, v52, v53
v_cvt_pk_bf16_f32 v171, v54, v55
ds_write_b128 v43, v[168:171] offset:10240
v_sub_f32 v56, v56, v222
v_sub_f32 v57, v57, v222
v_mfma_f32_32x32x16_bf16 v[112:127], a[28:31], v[132:135], v[112:127]
v_sub_f32 v58, v58, v222
v_sub_f32 v59, v59, v222
v_sub_f32 v60, v60, v222
v_sub_f32 v61, v61, v222
v_sub_f32 v62, v62, v222
v_sub_f32 v63, v63, v222
v_exp_f32 v56, v56
v_mfma_f32_32x32x16_bf16 v[112:127], a[44:47], v[136:139], v[112:127]
v_exp_f32 v57, v57
v_exp_f32 v58, v58
v_exp_f32 v59, v59
v_exp_f32 v60, v60
v_mfma_f32_32x32x16_bf16 v[112:127], a[60:63], v[140:143], v[112:127]
v_exp_f32 v61, v61
v_exp_f32 v62, v62
v_exp_f32 v63, v63
v_cvt_pk_bf16_f32 v172, v56, v57
v_mfma_f32_32x32x16_bf16 v[112:127], a[76:79], v[144:147], v[112:127]
v_cvt_pk_bf16_f32 v173, v58, v59
v_cvt_pk_bf16_f32 v174, v60, v61
v_cvt_pk_bf16_f32 v175, v62, v63
ds_write_b128 v43, v[172:175] offset:11264
v_mfma_f32_32x32x16_bf16 v[112:127], a[92:95], v[148:151], v[112:127]
s_waitcnt lgkmcnt(0)
s_barrier
ds_read_b128 v[12:15], v40 offset:10240
ds_read_b128 v[218:221], v46 offset:10240
ds_read_b128 v[176:179], v42 offset:10240
v_mfma_f32_32x32x16_bf16 v[112:127], a[108:111], v[152:155], v[112:127]
ds_read_b128 v[180:183], v42 offset:11264
ds_read_b128 v[184:187], v42 offset:12288
ds_read_b128 v[188:191], v42 offset:13312
v_mfma_f32_32x32x16_bf16 v[112:127], a[124:127], v[156:159], v[112:127]
ds_read_b128 v[192:195], v42 offset:14336
ds_read_b128 v[196:199], v42 offset:15360
ds_read_b128 v[200:203], v42 offset:16384
ds_read_b128 v[204:207], v42 offset:17408
s_waitcnt lgkmcnt(8)
v_max3_f32 v9, v12, v13, v14
v_max3_f32 v10, v219, v220, v221
v_max3_f32 v9, v9, v15, v218
v_max_f32 v9, v9, v10
v_cmp_neq_f32 vcc, v9, v44
s_cbranch_vccnz L_A_slow
L_A_back:
s_waitcnt lgkmcnt(7)
v_mfma_f32_32x32x16_bf16 v[64:79], a[0:3], v[176:179], v[64:79]
ds_read_b64_tr_b16 a[40:41], v28 offset:32768
ds_read_b64_tr_b16 a[42:43], v29 offset:40960
ds_read_b64_tr_b16 a[56:57], v28 offset:49152
s_waitcnt lgkmcnt(9)
v_mfma_f32_32x32x16_bf16 v[64:79], a[16:19], v[180:183], v[64:79]
ds_read_b64_tr_b16 a[58:59], v29 offset:57344
ds_read_b64_tr_b16 a[72:73], v36 offset:0
ds_read_b64_tr_b16 a[74:75], v37 offset:8192
s_waitcnt lgkmcnt(11)
v_mfma_f32_32x32x16_bf16 v[64:79], a[32:35], v[184:187], v[64:79]
ds_read_b64_tr_b16 a[88:89], v36 offset:16384
ds_read_b64_tr_b16 a[90:91], v37 offset:24576
ds_read_b64_tr_b16 a[104:105], v36 offset:32768
s_waitcnt lgkmcnt(13)
v_mfma_f32_32x32x16_bf16 v[64:79], a[48:51], v[188:191], v[64:79]
ds_read_b64_tr_b16 a[106:107], v37 offset:40960
ds_read_b64_tr_b16 a[120:121], v36 offset:49152
ds_read_b64_tr_b16 a[122:123], v37 offset:57344
s_waitcnt lgkmcnt(14)
v_mfma_f32_32x32x16_bf16 v[64:79], a[64:67], v[192:195], v[64:79]
ds_read_b64_tr_b16 a[12:13], v30 offset:0
ds_read_b64_tr_b16 a[14:15], v31 offset:8192
ds_read_b64_tr_b16 a[28:29], v30 offset:16384
v_mfma_f32_32x32x16_bf16 v[64:79], a[80:83], v[196:199], v[64:79]
ds_read_b64_tr_b16 a[30:31], v31 offset:24576
ds_read_b64_tr_b16 a[44:45], v30 offset:32768
ds_read_b64_tr_b16 a[46:47], v31 offset:40960
s_waitcnt lgkmcnt(14)
v_mfma_f32_32x32x16_bf16 v[64:79], a[96:99], v[200:203], v[64:79]
ds_read_b64_tr_b16 a[60:61], v30 offset:49152
ds_read_b64_tr_b16 a[62:63], v31 offset:57344
ds_read_b64_tr_b16 a[76:77], v38 offset:0
v_mfma_f32_32x32x16_bf16 v[64:79], a[112:115], v[204:207], v[64:79]
ds_read_b64_tr_b16 a[78:79], v39 offset:8192
ds_read_b64_tr_b16 a[92:93], v38 offset:16384
ds_read_b64_tr_b16 a[94:95], v39 offset:24576
v_mfma_f32_32x32x16_bf16 v[80:95], a[4:7], v[176:179], v[80:95]
ds_read_b64_tr_b16 a[108:109], v38 offset:32768
ds_read_b64_tr_b16 a[110:111], v39 offset:40960
ds_read_b64_tr_b16 a[124:125], v38 offset:49152
s_nop 0
v_mfma_f32_32x32x16_bf16 v[80:95], a[20:23], v[180:183], v[80:95]
ds_read_b64_tr_b16 a[126:127], v39 offset:57344
s_nop 2
v_mfma_f32_32x32x16_bf16 v[80:95], a[36:39], v[184:187], v[80:95]
s_nop 3
v_mfma_f32_32x32x16_bf16 v[80:95], a[52:55], v[188:191], v[80:95]
v_cvt_pk_bf16_f32 v128, v64, v65
v_cvt_pk_bf16_f32 v129, v66, v67
v_cvt_pk_bf16_f32 v130, v68, v69
v_cvt_pk_bf16_f32 v131, v70, v71
v_mfma_f32_32x32x16_bf16 v[80:95], a[68:71], v[192:195], v[80:95]
ds_write_b128 v208, v[128:131] offset:0
v_cvt_pk_bf16_f32 v132, v72, v73
v_cvt_pk_bf16_f32 v133, v74, v75
v_cvt_pk_bf16_f32 v134, v76, v77
v_mfma_f32_32x32x16_bf16 v[80:95], a[84:87], v[196:199], v[80:95]
v_cvt_pk_bf16_f32 v135, v78, v79
ds_write_b128 v209, v[132:135] offset:0
v_mfma_f32_32x32x16_bf16 v[80:95], a[100:103], v[200:203], v[80:95]
v_mfma_f32_32x32x16_bf16 v[80:95], a[116:119], v[204:207], v[80:95]
v_mfma_f32_32x32x16_bf16 v[96:111], a[8:11], v[176:179], v[96:111]
s_nop 3
v_mfma_f32_32x32x16_bf16 v[96:111], a[24:27], v[180:183], v[96:111]
s_nop 3
v_mfma_f32_32x32x16_bf16 v[96:111], a[40:43], v[184:187], v[96:111]
s_nop 3
v_mfma_f32_32x32x16_bf16 v[96:111], a[56:59], v[188:191], v[96:111]
v_cvt_pk_bf16_f32 v136, v80, v81
v_cvt_pk_bf16_f32 v137, v82, v83
v_cvt_pk_bf16_f32 v138, v84, v85
v_cvt_pk_bf16_f32 v139, v86, v87
s_waitcnt lgkmcnt(14)
v_mfma_f32_32x32x16_bf16 v[96:111], a[72:75], v[192:195], v[96:111]
ds_write_b128 v210, v[136:139] offset:0
v_cvt_pk_bf16_f32 v140, v88, v89
v_cvt_pk_bf16_f32 v141, v90, v91
v_cvt_pk_bf16_f32 v142, v92, v93
v_mfma_f32_32x32x16_bf16 v[96:111], a[88:91], v[196:199], v[96:111]
v_cvt_pk_bf16_f32 v143, v94, v95
ds_write_b128 v211, v[140:143] offset:0
ds_read_b128 v[224:227], v212 offset:0
ds_read_b128 v[228:231], v212 offset:8192
v_mfma_f32_32x32x16_bf16 v[96:111], a[104:107], v[200:203], v[96:111]
ds_read_b128 v[232:235], v212 offset:16384
ds_read_b128 v[236:239], v212 offset:24576
s_waitcnt lgkmcnt(3)
s_add_u32 s63, s65, 0
buffer_store_dwordx4 v[224:227], v213, s[4:7], s63 offen offset:0 sc1
v_mfma_f32_32x32x16_bf16 v[96:111], a[120:123], v[204:207], v[96:111]
s_waitcnt lgkmcnt(2)
s_add_u32 s63, s65, 262144
buffer_store_dwordx4 v[228:231], v213, s[4:7], s63 offen offset:0 sc1
v_mfma_f32_32x32x16_bf16 v[112:127], a[12:15], v[176:179], v[112:127]
s_waitcnt lgkmcnt(1)
s_add_u32 s63, s65, 524288
buffer_store_dwordx4 v[232:235], v213, s[4:7], s63 offen offset:0 sc1
s_nop 0
v_mfma_f32_32x32x16_bf16 v[112:127], a[28:31], v[180:183], v[112:127]
s_waitcnt lgkmcnt(0)
s_add_u32 s63, s65, 786432
buffer_store_dwordx4 v[236:239], v213, s[4:7], s63 offen offset:0 sc1
s_nop 0
v_mfma_f32_32x32x16_bf16 v[112:127], a[44:47], v[184:187], v[112:127]
s_nop 3
v_mfma_f32_32x32x16_bf16 v[112:127], a[60:63], v[188:191], v[112:127]
v_cvt_pk_bf16_f32 v128, v96, v97
v_cvt_pk_bf16_f32 v129, v98, v99
v_cvt_pk_bf16_f32 v130, v100, v101
v_cvt_pk_bf16_f32 v131, v102, v103
v_mfma_f32_32x32x16_bf16 v[112:127], a[76:79], v[192:195], v[112:127]
ds_write_b128 v208, v[128:131] offset:128
v_cvt_pk_bf16_f32 v132, v104, v105
v_cvt_pk_bf16_f32 v133, v106, v107
v_cvt_pk_bf16_f32 v134, v108, v109
v_mfma_f32_32x32x16_bf16 v[112:127], a[92:95], v[196:199], v[112:127]
v_cvt_pk_bf16_f32 v135, v110, v111
ds_write_b128 v209, v[132:135] offset:128
v_mfma_f32_32x32x16_bf16 v[112:127], a[108:111], v[200:203], v[112:127]
v_mfma_f32_32x32x16_bf16 v[112:127], a[124:127], v[204:207], v[112:127]
s_nop 11
v_cvt_pk_bf16_f32 v136, v112, v113
v_cvt_pk_bf16_f32 v137, v114, v115
v_cvt_pk_bf16_f32 v138, v116, v117
v_cvt_pk_bf16_f32 v139, v118, v119
ds_write_b128 v210, v[136:139] offset:128
v_cvt_pk_bf16_f32 v140, v120, v121
v_cvt_pk_bf16_f32 v141, v122, v123
v_cvt_pk_bf16_f32 v142, v124, v125
v_cvt_pk_bf16_f32 v143, v126, v127
ds_write_b128 v211, v[140:143] offset:128
ds_read_b128 v[240:243], v212 offset:128
ds_read_b128 v[244:247], v212 offset:8320
ds_read_b128 v[248:251], v212 offset:16512
ds_read_b128 v[252:255], v212 offset:24704
s_waitcnt lgkmcnt(3)
s_add_u32 s63, s65, 0
buffer_store_dwordx4 v[240:243], v213, s[4:7], s63 offen offset:128 sc1
s_waitcnt lgkmcnt(2)
s_add_u32 s63, s65, 262144
buffer_store_dwordx4 v[244:247], v213, s[4:7], s63 offen offset:128 sc1
s_waitcnt lgkmcnt(1)
s_add_u32 s63, s65, 524288
buffer_store_dwordx4 v[248:251], v213, s[4:7], s63 offen offset:128 sc1
s_waitcnt lgkmcnt(0)
s_add_u32 s63, s65, 786432
buffer_store_dwordx4 v[252:255], v213, s[4:7], s63 offen offset:128 sc1
v_add_f32 v48, v48, v56
v_add_f32 v49, v49, v57
v_add_f32 v50, v50, v58
v_add_f32 v51, v51, v59
v_add_f32 v52, v52, v60
v_add_f32 v53, v53, v61
v_add_f32 v54, v54, v62
v_add_f32 v55, v55, v63
v_add_f32 v48, v48, v52
v_add_f32 v49, v49, v53
v_add_f32 v50, v50, v54
v_add_f32 v51, v51, v55
v_add_f32 v48, v48, v50
v_add_f32 v49, v49, v51
v_add_f32 v48, v48, v49
v_add_f32 v217, v217, v48
ds_write_b32 v41, v217 offset:1024
s_waitcnt lgkmcnt(0)
s_barrier
ds_read_b128 v[52:55], v40 offset:1024
ds_read_b128 v[56:59], v46 offset:1024
s_waitcnt lgkmcnt(0)
v_add_f32 v52, v52, v56
v_add_f32 v53, v53, v57
v_add_f32 v54, v54, v58
v_add_f32 v55, v55, v59
v_add_f32 v52, v52, v53
v_add_f32 v54, v54, v55
v_add_f32 v45, v52, v54
ds_bpermute_b32 v60, v215, v44
ds_bpermute_b32 v61, v215, v45
ds_bpermute_b32 v62, v215, v44
ds_bpermute_b32 v63, v215, v45
s_waitcnt lgkmcnt(0)
s_waitcnt vmcnt(0)
s_barrier
buffer_store_dwordx4 v[60:63], v214, s[4:7], s79 offen sc1
s_mov_b32 s66, s72
s_mov_b32 s67, s73
s_mov_b32 s56, s16
s_and_b32 s57, s17, 0xffff
s_mov_b32 s58, 4096
s_mov_b32 s59, 0x20000
v_add_u32 v7, 0, v1
v_mul_u32_u24 v8, 43691, v7
v_lshrrev_b32 v8, 18, v8
v_mul_u32_u24 v4, 2656, v8
v_lshl_add_u32 v4, v7, 4, v4
v_add_u32 v7, 64, v1
v_mul_u32_u24 v8, 43691, v7
v_lshrrev_b32 v8, 18, v8
v_mul_u32_u24 v5, 2656, v8
v_lshl_add_u32 v5, v7, 4, v5
v_add_u32 v7, 128, v1
v_mul_u32_u24 v8, 43691, v7
v_lshrrev_b32 v8, 18, v8
v_mul_u32_u24 v6, 2656, v8
v_lshl_add_u32 v6, v7, 4, v6
v_lshlrev_b32 v121, 11, v3
v_lshl_add_u32 v121, v2, 4, v121
v_lshlrev_b32 v122, 3, v3
v_mov_b32 v24, 0x3f803f80
v_mov_b32 v25, 0x3f803f80
v_mov_b32 v26, 0x3f803f80
v_mov_b32 v27, 0x3f803f80
v_lshlrev_b32 v8, 1, v3
v_xor_b32 v8, v8, v2
v_lshlrev_b32 v8, 4, v8
v_lshl_add_u32 v8, v3, 10, v8
v_xor_b32 v9, 0x80, v8
s_lshl_b32 s68, s3, 13
s_add_u32 s68, s68, 16384
v_bfe_u32 v11, v1, 2, 2
v_lshl_add_u32 v10, v3, 3, v11
v_lshlrev_b32 v10, 8, v10
v_and_b32 v12, 1, v3
v_lshl_add_u32 v12, v12, 2, v11
v_lshlrev_b32 v12, 1, v12
v_bfe_u32 v13, v1, 1, 1
v_xor_b32 v12, v12, v13
v_lshl_add_u32 v10, v12, 4, v10
v_and_b32 v13, 1, v1
v_lshl_add_u32 v10, v13, 3, v10
v_add_u32 v10, s68, v10
v_xor_b32 v112, 0, v10
v_xor_b32 v113, 32, v10
v_xor_b32 v114, 64, v10
v_xor_b32 v115, 96, v10
v_xor_b32 v116, 128, v10
v_xor_b32 v117, 160, v10
v_xor_b32 v118, 192, v10
v_xor_b32 v119, 224, v10
s_mov_b32 s70, 0xaaaaaaaa
s_mov_b32 s71, 0xaaaaaaaa
v_mov_b32 v29, 0x4444
v_mov_b32 v28, 0xeeee
v_cndmask_b32 v29, v29, v28, s[70:71]
v_and_b32 v10, 1, v3
v_lshlrev_b32 v10, 5, v10
v_lshrrev_b32 v12, 1, v3
v_lshl_add_u32 v10, v12, 2, v10
v_add_u32 v10, v10, v11
v_mul_u32_u24 v125, 96, v10
v_and_b32 v28, 3, v1
v_lshl_add_u32 v125, v28, 3, v125
s_mul_i32 s76, s3, 24576
s_add_u32 s76, s76, 57344
v_add_u32 v125, s76, v125
v_lshrrev_b32 v10, 2, v2
v_mov_b32 v12, 0xffff
v_cmp_gt_u32 vcc, 3, v10
v_min_u32 v10, 2, v10
s_nop 0
v_cndmask_b32 v12, 0, v12, vcc
v_cmp_eq_u32 vcc, 0, v28
s_nop 1
v_cndmask_b32 v16, 0, v12, vcc
v_cmp_eq_u32 vcc, 1, v28
s_nop 1
v_cndmask_b32 v17, 0, v12, vcc
v_cmp_eq_u32 vcc, 2, v28
s_nop 1
v_cndmask_b32 v18, 0, v12, vcc
v_cmp_eq_u32 vcc, 3, v28
s_nop 1
v_cndmask_b32 v19, 0, v12, vcc
v_or_b32 v12, 8, v10
v_lshlrev_b32 v30, 2, v28
v_lshlrev_b32 v30, v30, v12
v_or_b32 v30, 0x4444, v30
v_lshlrev_b32 v120, 3, v2
s_lshl_b32 s62, s3, 9
s_add_u32 s62, s62, 51200
v_add_u32 v120, s62, v120
v_lshlrev_b32 v126, 4, v2
s_lshl_b32 s62, s3, 10
s_add_u32 s62, s62, 53248
v_add_u32 v126, s62, v126
v_lshl_add_u32 v7, v3, 2, v28
v_lshl_add_u32 v7, v10, 4, v7
v_lshlrev_b32 v127, 3, v7
v_lshlrev_b32 v7, 4, v7
s_lshl_b32 s69, s67, 15
s_lshl_b32 s63, s3, 8
s_add_u32 s69, s69, s63
s_add_u32 s69, s69, 5242880
v_lshrrev_b32 v13, 1, v1
v_lshlrev_b32 v13, 10, v13
v_and_b32 v14, 1, v1
v_lshl_add_u32 v13, v14, 7, v13
v_lshlrev_b32 v123, 5, v2
v_and_b32 v10, 1, v3
v_lshl_add_u32 v123, v10, 4, v123
v_lshrrev_b32 v10, 1, v3
v_lshl_add_u32 v123, v10, 3, v123
s_lshl_b32 s74, s67, 5
s_add_u32 s74, s74, s66
s_lshl_b32 s74, s74, 11
s_lshl_b32 s63, s3, 9
s_add_u32 s74, s74, s63
s_add_u32 s74, s74, 6291456
s_mov_b32 s75, 0xbdd2d3e8
v_mov_b32 v124, 0xc0135761
v_mov_b32 v160, 0
v_mov_b32 v161, 0
v_mov_b32 v162, 0
v_mov_b32 v163, 0
v_mov_b32 v164, 0
v_mov_b32 v165, 0
v_mov_b32 v166, 0
v_mov_b32 v167, 0
v_mov_b32 v168, 0
v_mov_b32 v169, 0
v_mov_b32 v170, 0
v_mov_b32 v171, 0
v_mov_b32 v172, 0
v_mov_b32 v173, 0
v_mov_b32 v174, 0
v_mov_b32 v175, 0
v_mov_b32 v176, 0
v_mov_b32 v177, 0
v_mov_b32 v178, 0
v_mov_b32 v179, 0
v_mov_b32 v180, 0
v_mov_b32 v181, 0
v_mov_b32 v182, 0
v_mov_b32 v183, 0
v_mov_b32 v184, 0
v_mov_b32 v185, 0
v_mov_b32 v186, 0
v_mov_b32 v187, 0
v_mov_b32 v188, 0
v_mov_b32 v189, 0
v_mov_b32 v190, 0
v_mov_b32 v191, 0
s_cmp_lt_u32 s66, 29
s_cbranch_scc1 L_FW
s_cmp_lg_u32 s66, 31
s_cbranch_scc1 L_fin
s_lshl_b32 s62, s67, 10
s_lshl_b32 s63, s3, 8
s_add_u32 s62, s62, s63
buffer_load_dwordx2 v[96:97], v122, s[56:59], s62 offen offset:0
buffer_load_dwordx2 v[98:99], v122, s[56:59], s62 offen offset:32
buffer_load_dwordx2 v[100:101], v122, s[56:59], s62 offen offset:64
buffer_load_dwordx2 v[102:103], v122, s[56:59], s62 offen offset:96
buffer_load_dwordx2 v[104:105], v122, s[56:59], s62 offen offset:128
buffer_load_dwordx2 v[106:107], v122, s[56:59], s62 offen offset:160
buffer_load_dwordx2 v[108:109], v122, s[56:59], s62 offen offset:192
buffer_load_dwordx2 v[110:111], v122, s[56:59], s62 offen offset:224
s_waitcnt vmcnt(0)
v_lshlrev_b32 v128, 16, v96
v_and_b32 v129, 0xffff0000, v96
v_lshlrev_b32 v130, 16, v97
v_and_b32 v131, 0xffff0000, v97
v_lshlrev_b32 v132, 16, v98
v_and_b32 v133, 0xffff0000, v98
v_lshlrev_b32 v134, 16, v99
v_and_b32 v135, 0xffff0000, v99
v_lshlrev_b32 v136, 16, v100
v_and_b32 v137, 0xffff0000, v100
v_lshlrev_b32 v138, 16, v101
v_and_b32 v139, 0xffff0000, v101
v_lshlrev_b32 v140, 16, v102
v_and_b32 v141, 0xffff0000, v102
v_lshlrev_b32 v142, 16, v103
v_and_b32 v143, 0xffff0000, v103
v_lshlrev_b32 v144, 16, v104
v_and_b32 v145, 0xffff0000, v104
v_lshlrev_b32 v146, 16, v105
v_and_b32 v147, 0xffff0000, v105
v_lshlrev_b32 v148, 16, v106
v_and_b32 v149, 0xffff0000, v106
v_lshlrev_b32 v150, 16, v107
v_and_b32 v151, 0xffff0000, v107
v_lshlrev_b32 v152, 16, v108
v_and_b32 v153, 0xffff0000, v108
v_lshlrev_b32 v154, 16, v109
v_and_b32 v155, 0xffff0000, v109
v_lshlrev_b32 v156, 16, v110
v_and_b32 v157, 0xffff0000, v110
v_lshlrev_b32 v158, 16, v111
v_and_b32 v159, 0xffff0000, v111
s_branch L_FFN
L_FW:
s_lshl_b32 s62, s67, 10
s_lshl_b32 s63, s3, 8
s_add_u32 s62, s62, s63
buffer_load_dwordx2 v[96:97], v122, s[56:59], s62 offen offset:0
buffer_load_dwordx2 v[98:99], v122, s[56:59], s62 offen offset:32
buffer_load_dwordx2 v[100:101], v122, s[56:59], s62 offen offset:64
buffer_load_dwordx2 v[102:103], v122, s[56:59], s62 offen offset:96
buffer_load_dwordx2 v[104:105], v122, s[56:59], s62 offen offset:128
buffer_load_dwordx2 v[106:107], v122, s[56:59], s62 offen offset:160
buffer_load_dwordx2 v[108:109], v122, s[56:59], s62 offen offset:192
buffer_load_dwordx2 v[110:111], v122, s[56:59], s62 offen offset:224
s_waitcnt vmcnt(0)
s_mul_i32 s62, s3, 352256
s_mul_i32 s63, s66, 96
s_mov_b32 m0, s76
s_add_u32 s62, s62, s63
buffer_load_dwordx4 v4, s[44:47], s62 offen lds
s_addk_i32 m0, 0x3000
s_nop 0
buffer_load_dwordx4 v4, s[48:51], s62 offen lds
s_addk_i32 m0, 0xd400
s_nop 0
buffer_load_dwordx4 v5, s[44:47], s62 offen lds
s_addk_i32 m0, 0x3000
s_nop 0
buffer_load_dwordx4 v5, s[48:51], s62 offen lds
s_addk_i32 m0, 0xd400
s_nop 0
buffer_load_dwordx4 v6, s[44:47], s62 offen lds
s_addk_i32 m0, 0x3000
s_nop 0
buffer_load_dwordx4 v6, s[48:51], s62 offen lds
s_addk_i32 m0, 0xd400
s_add_u32 s62, s62, 88064
buffer_load_dwordx4 v4, s[44:47], s62 offen lds
s_addk_i32 m0, 0x3000
s_nop 0
buffer_load_dwordx4 v4, s[48:51], s62 offen lds
s_addk_i32 m0, 0xd400
s_nop 0
buffer_load_dwordx4 v5, s[44:47], s62 offen lds
s_addk_i32 m0, 0x3000
s_nop 0
buffer_load_dwordx4 v5, s[48:51], s62 offen lds
s_addk_i32 m0, 0xd400
s_nop 0
buffer_load_dwordx4 v6, s[44:47], s62 offen lds
s_addk_i32 m0, 0x3000
s_nop 0
buffer_load_dwordx4 v6, s[48:51], s62 offen lds
s_addk_i32 m0, 0xd400
s_add_u32 s62, s62, 88064
buffer_load_dwordx4 v4, s[44:47], s62 offen lds
s_addk_i32 m0, 0x3000
s_nop 0
buffer_load_dwordx4 v4, s[48:51], s62 offen lds
s_addk_i32 m0, 0xd400
s_nop 0
buffer_load_dwordx4 v5, s[44:47], s62 offen lds
s_addk_i32 m0, 0x3000
s_nop 0
buffer_load_dwordx4 v5, s[48:51], s62 offen lds
s_addk_i32 m0, 0xd400
s_nop 0
buffer_load_dwordx4 v6, s[44:47], s62 offen lds
s_addk_i32 m0, 0x3000
s_nop 0
buffer_load_dwordx4 v6, s[48:51], s62 offen lds
s_addk_i32 m0, 0xd400
s_add_u32 s62, s62, 88064
buffer_load_dwordx4 v4, s[44:47], s62 offen lds
s_addk_i32 m0, 0x3000
s_nop 0
buffer_load_dwordx4 v4, s[48:51], s62 offen lds
s_addk_i32 m0, 0xd400
s_nop 0
buffer_load_dwordx4 v5, s[44:47], s62 offen lds
s_addk_i32 m0, 0x3000
s_nop 0
buffer_load_dwordx4 v5, s[48:51], s62 offen lds
s_addk_i32 m0, 0xd400
s_nop 0
buffer_load_dwordx4 v6, s[44:47], s62 offen lds
s_addk_i32 m0, 0x3000
s_nop 0
buffer_load_dwordx4 v6, s[48:51], s62 offen lds
s_mul_i32 s62, s66, 49152
s_lshl_b32 s63, s3, 8
s_add_u32 s62, s62, s63
s_add_u32 s63, s62, 0
buffer_load_dwordx4 v[192:195], v121, s[52:55], s63 offen offset:0
buffer_load_dwordx4 v[196:199], v121, s[52:55], s63 offen offset:1024
s_add_u32 s63, s62, 16384
buffer_load_dwordx4 v[200:203], v121, s[52:55], s63 offen offset:0
buffer_load_dwordx4 v[204:207], v121, s[52:55], s63 offen offset:1024
s_add_u32 s63, s62, 32768
buffer_load_dwordx4 v[208:211], v121, s[52:55], s63 offen offset:0
buffer_load_dwordx4 v[212:215], v121, s[52:55], s63 offen offset:1024
s_add_u32 s63, s62, 8192
buffer_load_dwordx4 v[216:219], v121, s[52:55], s63 offen offset:0
buffer_load_dwordx4 v[220:223], v121, s[52:55], s63 offen offset:1024
s_add_u32 s63, s62, 24576
buffer_load_dwordx4 v[224:227], v121, s[52:55], s63 offen offset:0
buffer_load_dwordx4 v[228:231], v121, s[52:55], s63 offen offset:1024
s_add_u32 s63, s62, 40960
buffer_load_dwordx4 v[232:235], v121, s[52:55], s63 offen offset:0
buffer_load_dwordx4 v[236:239], v121, s[52:55], s63 offen offset:1024
s_waitcnt vmcnt(36)
v_lshlrev_b32 v128, 16, v96
v_and_b32 v129, 0xffff0000, v96
v_lshlrev_b32 v130, 16, v97
v_and_b32 v131, 0xffff0000, v97
v_lshlrev_b32 v132, 16, v98
v_and_b32 v133, 0xffff0000, v98
v_lshlrev_b32 v134, 16, v99
v_and_b32 v135, 0xffff0000, v99
v_lshlrev_b32 v136, 16, v100
v_and_b32 v137, 0xffff0000, v100
v_lshlrev_b32 v138, 16, v101
v_and_b32 v139, 0xffff0000, v101
v_lshlrev_b32 v140, 16, v102
v_and_b32 v141, 0xffff0000, v102
v_lshlrev_b32 v142, 16, v103
v_and_b32 v143, 0xffff0000, v103
v_lshlrev_b32 v144, 16, v104
v_and_b32 v145, 0xffff0000, v104
v_lshlrev_b32 v146, 16, v105
v_and_b32 v147, 0xffff0000, v105
v_lshlrev_b32 v148, 16, v106
v_and_b32 v149, 0xffff0000, v106
v_lshlrev_b32 v150, 16, v107
v_and_b32 v151, 0xffff0000, v107
v_lshlrev_b32 v152, 16, v108
v_and_b32 v153, 0xffff0000, v108
v_lshlrev_b32 v154, 16, v109
v_and_b32 v155, 0xffff0000, v109
v_lshlrev_b32 v156, 16, v110
v_and_b32 v157, 0xffff0000, v110
v_lshlrev_b32 v158, 16, v111
v_and_b32 v159, 0xffff0000, v111
s_waitcnt vmcnt(24)
ds_read_b64_tr_b16 a[0:1], v125 offset:0
ds_read_b64_tr_b16 a[2:3], v125 offset:1536
ds_read_b64_tr_b16 a[4:5], v125 offset:768
ds_read_b64_tr_b16 a[6:7], v125 offset:2304
ds_read_b64_tr_b16 a[8:9], v125 offset:32
ds_read_b64_tr_b16 a[10:11], v125 offset:1568
ds_read_b64_tr_b16 a[12:13], v125 offset:800
ds_read_b64_tr_b16 a[14:15], v125 offset:2336
ds_read_b64_tr_b16 a[16:17], v125 offset:64
ds_read_b64_tr_b16 a[18:19], v125 offset:1600
ds_read_b64_tr_b16 a[20:21], v125 offset:832
ds_read_b64_tr_b16 a[22:23], v125 offset:2368
ds_read_b64_tr_b16 a[24:25], v125 offset:12288
ds_read_b64_tr_b16 a[26:27], v125 offset:13824
ds_read_b64_tr_b16 a[28:29], v125 offset:13056
ds_read_b64_tr_b16 a[30:31], v125 offset:14592
ds_read_b64_tr_b16 a[32:33], v125 offset:12320
ds_read_b64_tr_b16 a[34:35], v125 offset:13856
ds_read_b64_tr_b16 a[36:37], v125 offset:13088
ds_read_b64_tr_b16 a[38:39], v125 offset:14624
ds_read_b64_tr_b16 a[40:41], v125 offset:12352
ds_read_b64_tr_b16 a[42:43], v125 offset:13888
ds_read_b64_tr_b16 a[44:45], v125 offset:13120
ds_read_b64_tr_b16 a[46:47], v125 offset:14656
s_waitcnt vmcnt(12)
ds_read_b64_tr_b16 a[48:49], v125 offset:6144
ds_read_b64_tr_b16 a[50:51], v125 offset:7680
ds_read_b64_tr_b16 a[52:53], v125 offset:6912
ds_read_b64_tr_b16 a[54:55], v125 offset:8448
ds_read_b64_tr_b16 a[56:57], v125 offset:6176
ds_read_b64_tr_b16 a[58:59], v125 offset:7712
ds_read_b64_tr_b16 a[60:61], v125 offset:6944
ds_read_b64_tr_b16 a[62:63], v125 offset:8480
ds_read_b64_tr_b16 a[64:65], v125 offset:6208
ds_read_b64_tr_b16 a[66:67], v125 offset:7744
ds_read_b64_tr_b16 a[68:69], v125 offset:6976
ds_read_b64_tr_b16 a[70:71], v125 offset:8512
ds_read_b64_tr_b16 a[72:73], v125 offset:18432
ds_read_b64_tr_b16 a[74:75], v125 offset:19968
ds_read_b64_tr_b16 a[76:77], v125 offset:19200
ds_read_b64_tr_b16 a[78:79], v125 offset:20736
ds_read_b64_tr_b16 a[80:81], v125 offset:18464
ds_read_b64_tr_b16 a[82:83], v125 offset:20000
ds_read_b64_tr_b16 a[84:85], v125 offset:19232
ds_read_b64_tr_b16 a[86:87], v125 offset:20768
ds_read_b64_tr_b16 a[88:89], v125 offset:18496
ds_read_b64_tr_b16 a[90:91], v125 offset:20032
ds_read_b64_tr_b16 a[92:93], v125 offset:19264
ds_read_b64_tr_b16 a[94:95], v125 offset:20800
s_waitcnt lgkmcnt(0)
v_mfma_f32_16x16x32_bf16 v[32:35], v[24:27], a[0:3], 0
v_mfma_f32_16x16x32_bf16 v[36:39], v[24:27], a[8:11], 0
v_mfma_f32_16x16x32_bf16 v[40:43], v[24:27], a[16:19], 0
v_mfma_f32_16x16x32_bf16 v[44:47], v[24:27], a[24:27], 0
v_mfma_f32_16x16x32_bf16 v[48:51], v[24:27], a[32:35], 0
v_mfma_f32_16x16x32_bf16 v[52:55], v[24:27], a[40:43], 0
v_mfma_f32_16x16x32_bf16 v[32:35], v[24:27], a[4:7], v[32:35]
v_mfma_f32_16x16x32_bf16 v[36:39], v[24:27], a[12:15], v[36:39]
v_mfma_f32_16x16x32_bf16 v[40:43], v[24:27], a[20:23], v[40:43]
v_mfma_f32_16x16x32_bf16 v[44:47], v[24:27], a[28:31], v[44:47]
v_mfma_f32_16x16x32_bf16 v[48:51], v[24:27], a[36:39], v[48:51]
v_mfma_f32_16x16x32_bf16 v[52:55], v[24:27], a[44:47], v[52:55]
v_mfma_f32_16x16x32_bf16 v[32:35], v[24:27], a[48:51], v[32:35]
v_mfma_f32_16x16x32_bf16 v[36:39], v[24:27], a[56:59], v[36:39]
v_mfma_f32_16x16x32_bf16 v[40:43], v[24:27], a[64:67], v[40:43]
v_mfma_f32_16x16x32_bf16 v[44:47], v[24:27], a[72:75], v[44:47]
v_mfma_f32_16x16x32_bf16 v[48:51], v[24:27], a[80:83], v[48:51]
v_mfma_f32_16x16x32_bf16 v[52:55], v[24:27], a[88:91], v[52:55]
v_mfma_f32_16x16x32_bf16 v[32:35], v[24:27], a[52:55], v[32:35]
v_mfma_f32_16x16x32_bf16 v[36:39], v[24:27], a[60:63], v[36:39]
v_mfma_f32_16x16x32_bf16 v[40:43], v[24:27], a[68:71], v[40:43]
v_mfma_f32_16x16x32_bf16 v[44:47], v[24:27], a[76:79], v[44:47]
v_mfma_f32_16x16x32_bf16 v[48:51], v[24:27], a[84:87], v[48:51]
v_mfma_f32_16x16x32_bf16 v[52:55], v[24:27], a[92:95], v[52:55]
s_waitcnt vmcnt(0)
v_perm_b32 v64, v200, v192, s60
v_perm_b32 v65, v208, v208, s60
v_perm_b32 v66, v204, v196, s60
v_perm_b32 v67, v212, v212, s60
v_accvgpr_write_b32 a96, v64
v_accvgpr_write_b32 a97, v65
v_accvgpr_write_b32 a98, v66
v_accvgpr_write_b32 a99, v67
v_perm_b32 v64, v200, v192, s61
v_perm_b32 v65, v208, v208, s61
v_perm_b32 v66, v204, v196, s61
v_perm_b32 v67, v212, v212, s61
v_accvgpr_write_b32 a104, v64
v_accvgpr_write_b32 a105, v65
v_accvgpr_write_b32 a106, v66
v_accvgpr_write_b32 a107, v67
v_perm_b32 v64, v201, v193, s60
v_perm_b32 v65, v209, v209, s60
v_perm_b32 v66, v205, v197, s60
v_perm_b32 v67, v213, v213, s60
v_accvgpr_write_b32 a112, v64
v_accvgpr_write_b32 a113, v65
v_accvgpr_write_b32 a114, v66
v_accvgpr_write_b32 a115, v67
v_perm_b32 v64, v201, v193, s61
v_perm_b32 v65, v209, v209, s61
v_perm_b32 v66, v205, v197, s61
v_perm_b32 v67, v213, v213, s61
v_accvgpr_write_b32 a120, v64
v_accvgpr_write_b32 a121, v65
v_accvgpr_write_b32 a122, v66
v_accvgpr_write_b32 a123, v67
v_perm_b32 v64, v202, v194, s60
v_perm_b32 v65, v210, v210, s60
v_perm_b32 v66, v206, v198, s60
v_perm_b32 v67, v214, v214, s60
v_accvgpr_write_b32 a128, v64
v_accvgpr_write_b32 a129, v65
v_accvgpr_write_b32 a130, v66
v_accvgpr_write_b32 a131, v67
v_perm_b32 v64, v202, v194, s61
v_perm_b32 v65, v210, v210, s61
v_perm_b32 v66, v206, v198, s61
v_perm_b32 v67, v214, v214, s61
v_accvgpr_write_b32 a136, v64
v_accvgpr_write_b32 a137, v65
v_accvgpr_write_b32 a138, v66
v_accvgpr_write_b32 a139, v67
v_perm_b32 v64, v203, v195, s60
v_perm_b32 v65, v211, v211, s60
v_perm_b32 v66, v207, v199, s60
v_perm_b32 v67, v215, v215, s60
v_accvgpr_write_b32 a144, v64
v_accvgpr_write_b32 a145, v65
v_accvgpr_write_b32 a146, v66
v_accvgpr_write_b32 a147, v67
v_perm_b32 v64, v203, v195, s61
v_perm_b32 v65, v211, v211, s61
v_perm_b32 v66, v207, v199, s61
v_perm_b32 v67, v215, v215, s61
v_accvgpr_write_b32 a152, v64
v_accvgpr_write_b32 a153, v65
v_accvgpr_write_b32 a154, v66
v_accvgpr_write_b32 a155, v67
ds_write2_b32 v120, v32, v44 offset0:0 offset1:1
ds_write2_b32 v120, v36, v48 offset0:32 offset1:33
ds_write2_b32 v120, v40, v52 offset0:64 offset1:65
v_perm_b32 v64, v224, v216, s60
v_perm_b32 v65, v232, v232, s60
v_perm_b32 v66, v228, v220, s60
v_perm_b32 v67, v236, v236, s60
v_accvgpr_write_b32 a100, v64
v_accvgpr_write_b32 a101, v65
v_accvgpr_write_b32 a102, v66
v_accvgpr_write_b32 a103, v67
v_perm_b32 v64, v224, v216, s61
v_perm_b32 v65, v232, v232, s61
v_perm_b32 v66, v228, v220, s61
v_perm_b32 v67, v236, v236, s61
v_accvgpr_write_b32 a108, v64
v_accvgpr_write_b32 a109, v65
v_accvgpr_write_b32 a110, v66
v_accvgpr_write_b32 a111, v67
v_perm_b32 v64, v225, v217, s60
v_perm_b32 v65, v233, v233, s60
v_perm_b32 v66, v229, v221, s60
v_perm_b32 v67, v237, v237, s60
v_accvgpr_write_b32 a116, v64
v_accvgpr_write_b32 a117, v65
v_accvgpr_write_b32 a118, v66
v_accvgpr_write_b32 a119, v67
v_perm_b32 v64, v225, v217, s61
v_perm_b32 v65, v233, v233, s61
v_perm_b32 v66, v229, v221, s61
v_perm_b32 v67, v237, v237, s61
v_accvgpr_write_b32 a124, v64
v_accvgpr_write_b32 a125, v65
v_accvgpr_write_b32 a126, v66
v_accvgpr_write_b32 a127, v67
v_perm_b32 v64, v226, v218, s60
v_perm_b32 v65, v234, v234, s60
v_perm_b32 v66, v230, v222, s60
v_perm_b32 v67, v238, v238, s60
v_accvgpr_write_b32 a132, v64
v_accvgpr_write_b32 a133, v65
v_accvgpr_write_b32 a134, v66
v_accvgpr_write_b32 a135, v67
v_perm_b32 v64, v226, v218, s61
v_perm_b32 v65, v234, v234, s61
v_perm_b32 v66, v230, v222, s61
v_perm_b32 v67, v238, v238, s61
v_accvgpr_write_b32 a140, v64
v_accvgpr_write_b32 a141, v65
v_accvgpr_write_b32 a142, v66
v_accvgpr_write_b32 a143, v67
v_perm_b32 v64, v227, v219, s60
v_perm_b32 v65, v235, v235, s60
v_perm_b32 v66, v231, v223, s60
v_perm_b32 v67, v239, v239, s60
v_accvgpr_write_b32 a148, v64
v_accvgpr_write_b32 a149, v65
v_accvgpr_write_b32 a150, v66
v_accvgpr_write_b32 a151, v67
v_perm_b32 v64, v227, v219, s61
v_perm_b32 v65, v235, v235, s61
v_perm_b32 v66, v231, v223, s61
v_perm_b32 v67, v239, v239, s61
v_accvgpr_write_b32 a156, v64
v_accvgpr_write_b32 a157, v65
v_accvgpr_write_b32 a158, v66
v_accvgpr_write_b32 a159, v67
s_waitcnt lgkmcnt(0)
s_barrier
ds_read_b64 v[32:33], v127 offset:51200
ds_read_b64 v[34:35], v127 offset:51712
ds_read_b64 v[36:37], v127 offset:52224
ds_read_b64 v[38:39], v127 offset:52736
s_waitcnt lgkmcnt(0)
v_add_f32 v32, v32, v34
v_add_f32 v36, v36, v38
v_add_f32 v224, v32, v36
v_add_f32 v33, v33, v35
v_add_f32 v37, v37, v39
v_add_f32 v225, v33, v37
L_FFN:
s_mov_b32 s65, 100000
fp_23:
v_mov_b32 v192, 0
v_mov_b32 v193, 0
v_mov_b32 v194, 0
v_mov_b32 v195, 0
v_mov_b32 v196, 0
v_mov_b32 v197, 0
v_mov_b32 v198, 0
v_mov_b32 v199, 0
v_mov_b32 v200, 0
v_mov_b32 v201, 0
v_mov_b32 v202, 0
v_mov_b32 v203, 0
v_mov_b32 v204, 0
v_mov_b32 v205, 0
v_mov_b32 v206, 0
v_mov_b32 v207, 0
v_mov_b32 v208, 0
v_mov_b32 v209, 0
v_mov_b32 v210, 0
v_mov_b32 v211, 0
v_mov_b32 v212, 0
v_mov_b32 v213, 0
v_mov_b32 v214, 0
v_mov_b32 v215, 0
s_mov_b32 s64, 400000
s_branch plf_27
pl_25:
s_sleep 1
plf_27:
buffer_load_dword v14, v13, s[4:7], s69 offen sc1
s_sub_u32 s64, s64, 1
s_cmp_eq_u32 s64, 0
s_waitcnt vmcnt(0)
s_cbranch_scc1 ple_26
v_cmp_eq_u32 vcc, -1, v14
s_cbranch_vccnz pl_25
ple_26:
L_FGO:
s_mov_b32 m0, s68
s_mov_b32 s63, s69
buffer_load_dwordx4 v8, s[4:7], s63 offen sc1 lds
s_addk_i32 m0, 0x400
s_addk_i32 s63, 0x1000
buffer_load_dwordx4 v8, s[4:7], s63 offen sc1 lds
s_addk_i32 m0, 0x400
s_addk_i32 s63, 0x1000
buffer_load_dwordx4 v9, s[4:7], s63 offen sc1 lds
s_addk_i32 m0, 0x400
s_addk_i32 s63, 0x1000
buffer_load_dwordx4 v9, s[4:7], s63 offen sc1 lds
s_addk_i32 m0, 0x400
s_addk_i32 s63, 0x1000
buffer_load_dwordx4 v8, s[4:7], s63 offen sc1 lds
s_addk_i32 m0, 0x400
s_addk_i32 s63, 0x1000
buffer_load_dwordx4 v8, s[4:7], s63 offen sc1 lds
s_addk_i32 m0, 0x400
s_addk_i32 s63, 0x1000
buffer_load_dwordx4 v9, s[4:7], s63 offen sc1 lds
s_addk_i32 m0, 0x400
s_addk_i32 s63, 0x1000
buffer_load_dwordx4 v9, s[4:7], s63 offen sc1 lds
s_waitcnt vmcnt(0)
ds_read_b64_tr_b16 v[32:33], v112
ds_read_b64_tr_b16 v[34:35], v112 offset:1024
ds_read_b64_tr_b16 v[36:37], v113
ds_read_b64_tr_b16 v[38:39], v113 offset:1024
ds_read_b64_tr_b16 v[40:41], v114
ds_read_b64_tr_b16 v[42:43], v114 offset:1024
ds_read_b64_tr_b16 v[44:45], v115
ds_read_b64_tr_b16 v[46:47], v115 offset:1024
ds_read_b64_tr_b16 v[48:49], v116
ds_read_b64_tr_b16 v[50:51], v116 offset:1024
ds_read_b64_tr_b16 v[52:53], v117
ds_read_b64_tr_b16 v[54:55], v117 offset:1024
s_waitcnt lgkmcnt(8)
ds_read_b64_tr_b16 v[56:57], v118
ds_read_b64_tr_b16 v[58:59], v118 offset:1024
ds_read_b64_tr_b16 v[60:61], v119
ds_read_b64_tr_b16 v[62:63], v119 offset:1024
s_waitcnt lgkmcnt(14)
v_mfma_f32_16x16x32_bf16 v[64:67], v[32:35], v[24:27], v[128:131]
s_waitcnt lgkmcnt(12)
v_mfma_f32_16x16x32_bf16 v[68:71], v[36:39], v[24:27], v[132:135]
s_waitcnt lgkmcnt(10)
v_mfma_f32_16x16x32_bf16 v[72:75], v[40:43], v[24:27], v[136:139]
s_waitcnt lgkmcnt(8)
v_mfma_f32_16x16x32_bf16 v[76:79], v[44:47], v[24:27], v[140:143]
s_waitcnt lgkmcnt(6)
v_mfma_f32_16x16x32_bf16 v[80:83], v[48:51], v[24:27], v[144:147]
s_waitcnt lgkmcnt(4)
v_mfma_f32_16x16x32_bf16 v[84:87], v[52:55], v[24:27], v[148:151]
s_waitcnt lgkmcnt(2)
v_mfma_f32_16x16x32_bf16 v[88:91], v[56:59], v[24:27], v[152:155]
s_waitcnt lgkmcnt(0)
v_mfma_f32_16x16x32_bf16 v[92:95], v[60:63], v[24:27], v[156:159]
v_cvt_pk_bf16_f32 v96, v64, v65
v_cvt_pk_bf16_f32 v97, v66, v67
v_cndmask_b32 v216, v96, v97, s[70:71]
v_cvt_pk_bf16_f32 v98, v68, v69
v_cvt_pk_bf16_f32 v99, v70, v71
v_cndmask_b32 v217, v98, v99, s[70:71]
v_cvt_pk_bf16_f32 v100, v72, v73
v_cvt_pk_bf16_f32 v101, v74, v75
v_cndmask_b32 v218, v100, v101, s[70:71]
v_cvt_pk_bf16_f32 v102, v76, v77
v_cvt_pk_bf16_f32 v103, v78, v79
v_cndmask_b32 v219, v102, v103, s[70:71]
v_mfma_f32_16x16x32_bf16 v[56:59], v[96:99], v[24:27], 0
v_mfma_f32_16x16x32_bf16 v[60:63], v[96:99], v[96:99], 0
v_cvt_pk_bf16_f32 v104, v80, v81
v_cvt_pk_bf16_f32 v105, v82, v83
v_cndmask_b32 v220, v104, v105, s[70:71]
v_smfmac_f32_16x16x64_bf16 v[192:195], v[216:219], a[0:7], v29
v_smfmac_f32_16x16x64_bf16 v[196:199], v[216:219], a[8:15], v29
v_cvt_pk_bf16_f32 v106, v84, v85
v_cvt_pk_bf16_f32 v107, v86, v87
v_cndmask_b32 v221, v106, v107, s[70:71]
v_smfmac_f32_16x16x64_bf16 v[200:203], v[216:219], a[16:23], v29
v_smfmac_f32_16x16x64_bf16 v[204:207], v[216:219], a[24:31], v29
v_cvt_pk_bf16_f32 v108, v88, v89
v_cvt_pk_bf16_f32 v109, v90, v91
v_cndmask_b32 v222, v108, v109, s[70:71]
v_smfmac_f32_16x16x64_bf16 v[208:211], v[216:219], a[32:39], v29
v_smfmac_f32_16x16x64_bf16 v[212:215], v[216:219], a[40:47], v29
v_cvt_pk_bf16_f32 v110, v92, v93
v_cvt_pk_bf16_f32 v111, v94, v95
v_cndmask_b32 v223, v110, v111, s[70:71]
v_mfma_f32_16x16x32_bf16 v[56:59], v[100:103], v[24:27], v[56:59]
v_mfma_f32_16x16x32_bf16 v[60:63], v[100:103], v[100:103], v[60:63]
v_mfma_f32_16x16x32_bf16 v[56:59], v[104:107], v[24:27], v[56:59]
v_mfma_f32_16x16x32_bf16 v[56:59], v[108:111], v[24:27], v[56:59]
v_mfma_f32_16x16x32_bf16 v[60:63], v[104:107], v[104:107], v[60:63]
v_mfma_f32_16x16x32_bf16 v[60:63], v[108:111], v[108:111], v[60:63]
s_cmp_ge_u32 s66, 29
s_cbranch_scc1 L_HPUB
v_smfmac_f32_16x16x64_bf16 v[192:195], v[220:223], a[48:55], v29
v_smfmac_f32_16x16x64_bf16 v[204:207], v[220:223], a[72:79], v29
v_smfmac_f32_16x16x64_bf16 v[196:199], v[220:223], a[56:63], v29
v_smfmac_f32_16x16x64_bf16 v[208:211], v[220:223], a[80:87], v29
v_smfmac_f32_16x16x64_bf16 v[200:203], v[220:223], a[64:71], v29
v_smfmac_f32_16x16x64_bf16 v[212:215], v[220:223], a[88:95], v29
s_sub_u32 s65, s65, 1
s_cmp_eq_u32 s65, 0
s_cbranch_scc1 fpe_24
v_cmp_u_f32 vcc, v56, v56
s_cbranch_vccnz fp_23
fpe_24:
s_mov_b64 exec, 0xffff
ds_write2_b32 v126, v56, v60 offset0:2 offset1:3
ds_write2_b32 v126, v56, v60 offset0:66 offset1:67
ds_write2_b32 v126, v56, v60 offset0:130 offset1:131
v_add_f32 v192, v192, v193
v_add_f32 v204, v204, v205
ds_write2_b32 v126, v192, v204 offset0:0 offset1:1
v_add_f32 v196, v196, v197
v_add_f32 v208, v208, v209
ds_write2_b32 v126, v196, v208 offset0:64 offset1:65
v_add_f32 v200, v200, v201
v_add_f32 v212, v212, v213
ds_write2_b32 v126, v200, v212 offset0:128 offset1:129
s_mov_b64 exec, -1
s_waitcnt lgkmcnt(0)
s_barrier
ds_read_b128 v[32:35], v7 offset:53248
ds_read_b128 v[36:39], v7 offset:54272
ds_read_b128 v[40:43], v7 offset:55296
ds_read_b128 v[44:47], v7 offset:56320
s_waitcnt lgkmcnt(2)
v_add_f32 v34, v34, v38
v_add_f32 v35, v35, v39
v_add_f32 v32, v32, v36
v_add_f32 v33, v33, v37
s_waitcnt lgkmcnt(0)
v_add_f32 v42, v42, v46
v_add_f32 v43, v43, v47
v_add_f32 v34, v34, v42
v_add_f32 v35, v35, v43
v_mul_f32 v34, 0x3b000000, v34
v_mul_f32 v35, 0x3b000000, v35
v_add_f32 v40, v40, v44
v_fma_f32 v35, -v34, v34, v35
v_add_f32 v41, v41, v45
v_max_f32 v35, 0, v35
v_add_f32 v32, v32, v40
v_cvt_pk_bf16_f32 v35, v34, v35
v_add_f32 v33, v33, v41
v_lshlrev_b32 v34, 16, v35
v_and_b32 v35, 0xffff0000, v35
v_add_f32 v35, 0x3727c5ac, v35
v_fma_f32 v32, -v34, v224, v32
v_cvt_pk_bf16_f32 v35, v35, v35
v_fma_f32 v33, -v34, v225, v33
v_lshlrev_b32 v35, 16, v35
v_sqrt_f32 v35, v35
s_nop 0
v_cvt_pk_bf16_f32 v35, v35, v35
v_lshlrev_b32 v35, 16, v35
v_rcp_f32 v35, v35
s_nop 0
v_mul_f32 v32, v35, v32
v_mul_f32 v33, v35, v33
v_cvt_pk_bf16_f32 v36, v32, v33
v_lshlrev_b32 v32, 16, v36
v_and_b32 v33, 0xffff0000, v36
v_mul_f32 v37, v32, v32
v_fma_f32 v37, v37, s75, v124
v_mul_f32 v37, v37, v32
v_exp_f32 v37, v37
s_nop 0
v_add_f32 v37, 1.0, v37
v_rcp_f32 v37, v37
s_nop 0
v_mul_f32 v37, v37, v32
v_cvt_pk_bf16_f32 v37, v37, v37
v_lshlrev_b32 v37, 16, v37
v_mul_f32 v37, v37, v33
v_cvt_pk_bf16_f32 v37, v37, v37
v_and_b32 v48, v37, v16
v_and_b32 v49, v37, v17
v_and_b32 v50, v37, v18
v_and_b32 v51, v37, v19
s_nop 1
v_smfmac_f32_16x16x64_bf16 v[160:163], v[48:51], a[96:103], v30
v_smfmac_f32_16x16x64_bf16 v[176:179], v[48:51], a[128:135], v30
v_smfmac_f32_16x16x64_bf16 v[168:171], v[48:51], a[112:119], v30
v_smfmac_f32_16x16x64_bf16 v[184:187], v[48:51], a[144:151], v30
v_smfmac_f32_16x16x64_bf16 v[164:167], v[48:51], a[104:111], v30
v_smfmac_f32_16x16x64_bf16 v[180:183], v[48:51], a[136:143], v30
v_smfmac_f32_16x16x64_bf16 v[172:175], v[48:51], a[120:127], v30
v_smfmac_f32_16x16x64_bf16 v[188:191], v[48:51], a[152:159], v30
s_nop 0
v_add_f32 v160, v160, v161
v_add_f32 v162, v162, v163
v_add_f32 v176, v176, v177
v_add_f32 v178, v178, v179
v_add_f32 v168, v168, v169
v_add_f32 v170, v170, v171
v_add_f32 v184, v184, v185
v_add_f32 v186, v186, v187
v_add_f32 v164, v164, v165
v_add_f32 v166, v166, v167
v_add_f32 v180, v180, v181
v_add_f32 v182, v182, v183
v_add_f32 v172, v172, v173
v_add_f32 v174, v174, v175
v_add_f32 v188, v188, v189
v_add_f32 v190, v190, v191
v_add_f32 v160, v160, v162
v_add_f32 v176, v176, v178
v_add_f32 v168, v168, v170
v_add_f32 v184, v184, v186
v_add_f32 v164, v164, v166
v_add_f32 v180, v180, v182
v_add_f32 v172, v172, v174
v_add_f32 v188, v188, v190
v_permlane16_swap_b32 v160, v176
v_permlane16_swap_b32 v168, v184
v_permlane16_swap_b32 v164, v180
v_permlane16_swap_b32 v172, v188
v_add_f32 v160, v160, v176
v_add_f32 v168, v168, v184
v_add_f32 v164, v164, v180
v_add_f32 v172, v172, v188
v_permlane32_swap_b32 v160, v168
s_nop 0
v_permlane32_swap_b32 v164, v172
v_add_f32 v32, v160, v168
v_add_f32 v33, v164, v172
buffer_store_dwordx2 v[32:33], v123, s[4:7], s74 offen sc1
L_fin:
L_end:
s_endpgm
L_A_slow:
s_waitcnt lgkmcnt(0)
v_sub_f32 v47, v44, v9
v_sub_f32 v222, v222, v9
v_mov_b32 v44, v9
v_exp_f32 v47, v47
v_exp_f32 v222, v222
v_sub_f32 v12, v44, v12
v_cvt_u32_f32 v8, v12
v_min_u32 v8, 0xff, v8
v_mul_u32_u24 v8, 0x800080, v8
v_pk_sub_u16 v176, v176, v8 clamp
v_pk_sub_u16 v177, v177, v8 clamp
v_pk_sub_u16 v178, v178, v8 clamp
v_pk_sub_u16 v179, v179, v8 clamp
v_pk_sub_u16 v180, v180, v8 clamp
v_pk_sub_u16 v181, v181, v8 clamp
v_pk_sub_u16 v182, v182, v8 clamp
v_pk_sub_u16 v183, v183, v8 clamp
v_sub_f32 v13, v44, v13
v_cvt_u32_f32 v9, v13
v_min_u32 v9, 0xff, v9
v_mul_u32_u24 v9, 0x800080, v9
v_pk_sub_u16 v184, v184, v9 clamp
v_pk_sub_u16 v185, v185, v9 clamp
v_pk_sub_u16 v186, v186, v9 clamp
v_pk_sub_u16 v187, v187, v9 clamp
v_pk_sub_u16 v188, v188, v9 clamp
v_pk_sub_u16 v189, v189, v9 clamp
v_pk_sub_u16 v190, v190, v9 clamp
v_pk_sub_u16 v191, v191, v9 clamp
v_sub_f32 v14, v44, v14
v_cvt_u32_f32 v10, v14
v_min_u32 v10, 0xff, v10
v_mul_u32_u24 v10, 0x800080, v10
v_pk_sub_u16 v192, v192, v10 clamp
v_pk_sub_u16 v193, v193, v10 clamp
v_pk_sub_u16 v194, v194, v10 clamp
v_pk_sub_u16 v195, v195, v10 clamp
v_pk_sub_u16 v196, v196, v10 clamp
v_pk_sub_u16 v197, v197, v10 clamp
v_pk_sub_u16 v198, v198, v10 clamp
v_pk_sub_u16 v199, v199, v10 clamp
v_sub_f32 v15, v44, v15
v_cvt_u32_f32 v11, v15
v_min_u32 v11, 0xff, v11
v_mul_u32_u24 v11, 0x800080, v11
v_pk_sub_u16 v200, v200, v11 clamp
v_pk_sub_u16 v201, v201, v11 clamp
v_pk_sub_u16 v202, v202, v11 clamp
v_pk_sub_u16 v203, v203, v11 clamp
v_pk_sub_u16 v204, v204, v11 clamp
v_pk_sub_u16 v205, v205, v11 clamp
v_pk_sub_u16 v206, v206, v11 clamp
v_pk_sub_u16 v207, v207, v11 clamp
v_mul_f32 v64, v47, v64
v_mul_f32 v65, v47, v65
v_mul_f32 v66, v47, v66
v_mul_f32 v67, v47, v67
v_mul_f32 v68, v47, v68
v_mul_f32 v69, v47, v69
v_mul_f32 v70, v47, v70
v_mul_f32 v71, v47, v71
v_mul_f32 v72, v47, v72
v_mul_f32 v73, v47, v73
v_mul_f32 v74, v47, v74
v_mul_f32 v75, v47, v75
v_mul_f32 v76, v47, v76
v_mul_f32 v77, v47, v77
v_mul_f32 v78, v47, v78
v_mul_f32 v79, v47, v79
v_mul_f32 v80, v47, v80
v_mul_f32 v81, v47, v81
v_mul_f32 v82, v47, v82
v_mul_f32 v83, v47, v83
v_mul_f32 v84, v47, v84
v_mul_f32 v85, v47, v85
v_mul_f32 v86, v47, v86
v_mul_f32 v87, v47, v87
v_mul_f32 v88, v47, v88
v_mul_f32 v89, v47, v89
v_mul_f32 v90, v47, v90
v_mul_f32 v91, v47, v91
v_mul_f32 v92, v47, v92
v_mul_f32 v93, v47, v93
v_mul_f32 v94, v47, v94
v_mul_f32 v95, v47, v95
v_mul_f32 v96, v47, v96
v_mul_f32 v97, v47, v97
v_mul_f32 v98, v47, v98
v_mul_f32 v99, v47, v99
v_mul_f32 v100, v47, v100
v_mul_f32 v101, v47, v101
v_mul_f32 v102, v47, v102
v_mul_f32 v103, v47, v103
v_mul_f32 v104, v47, v104
v_mul_f32 v105, v47, v105
v_mul_f32 v106, v47, v106
v_mul_f32 v107, v47, v107
v_mul_f32 v108, v47, v108
v_mul_f32 v109, v47, v109
v_mul_f32 v110, v47, v110
v_mul_f32 v111, v47, v111
v_mul_f32 v112, v47, v112
v_mul_f32 v113, v47, v113
v_mul_f32 v114, v47, v114
v_mul_f32 v115, v47, v115
v_mul_f32 v116, v47, v116
v_mul_f32 v117, v47, v117
v_mul_f32 v118, v47, v118
v_mul_f32 v119, v47, v119
v_mul_f32 v120, v47, v120
v_mul_f32 v121, v47, v121
v_mul_f32 v122, v47, v122
v_mul_f32 v123, v47, v123
v_mul_f32 v124, v47, v124
v_mul_f32 v125, v47, v125
v_mul_f32 v126, v47, v126
v_mul_f32 v127, v47, v127
v_mul_f32 v217, v47, v217
v_mul_f32 v48, v222, v48
v_mul_f32 v49, v222, v49
v_mul_f32 v50, v222, v50
v_mul_f32 v51, v222, v51
v_mul_f32 v52, v222, v52
v_mul_f32 v53, v222, v53
v_mul_f32 v54, v222, v54
v_mul_f32 v55, v222, v55
v_mul_f32 v56, v222, v56
v_mul_f32 v57, v222, v57
v_mul_f32 v58, v222, v58
v_mul_f32 v59, v222, v59
v_mul_f32 v60, v222, v60
v_mul_f32 v61, v222, v61
v_mul_f32 v62, v222, v62
v_mul_f32 v63, v222, v63
s_branch L_A_back
L_HPUB:
s_sub_u32 s65, s65, 1
s_cmp_eq_u32 s65, 0
s_cbranch_scc1 L_HPUB2
s_nop 3
v_cmp_u_f32 vcc, v56, v56
s_cbranch_vccnz fp_23
L_HPUB2:
v_lshlrev_b32 v13, 4, v3
s_mov_b32 s70, 0x00010001
s_mov_b32 s71, 0x00010001
s_mov_b64 exec, s[70:71]
buffer_store_dwordx4 v[64:67], v13, s[4:7], s74 offen offset:0 sc1
buffer_store_dwordx4 v[68:71], v13, s[4:7], s74 offen offset:64 sc1
buffer_store_dwordx4 v[72:75], v13, s[4:7], s74 offen offset:128 sc1
buffer_store_dwordx4 v[76:79], v13, s[4:7], s74 offen offset:192 sc1
buffer_store_dwordx4 v[80:83], v13, s[4:7], s74 offen offset:256 sc1
buffer_store_dwordx4 v[84:87], v13, s[4:7], s74 offen offset:320 sc1
buffer_store_dwordx4 v[88:91], v13, s[4:7], s74 offen offset:384 sc1
buffer_store_dwordx4 v[92:95], v13, s[4:7], s74 offen offset:448 sc1
s_mov_b64 exec, -1
s_branch L_fin
.section .rodata,"a"
.p2align 6
.amdhsa_kernel sequential_preLN__compressed_kv_cla__glu_gated_geglu__decode_kernel
  .amdhsa_next_free_vgpr 512
  .amdhsa_next_free_sgpr 102
  .amdhsa_accum_offset 256
  .amdhsa_group_segment_fixed_size 0
  .amdhsa_kernarg_size 104
  .amdhsa_user_sgpr_count 2
  .amdhsa_user_sgpr_kernarg_segment_ptr 1
  .amdhsa_system_sgpr_workgroup_id_x 1
.end_amdhsa_kernel
```
